```python
import torch

def _softmax(x, axis=-1):
    return torch.softmax(x, dim=axis)
def _gelu(x):
    return torch.nn.functional.gelu(x, approximate="tanh")
def _silu(x):
    return torch.nn.functional.silu(x)
def _sigmoid(x):
    return torch.sigmoid(x)
def _layernorm(x, axis=-1, eps=1e-5):
    m = x.mean(dim=axis, keepdim=True)
    v = x.var(dim=axis, keepdim=True, unbiased=False)
    return (x - m) / torch.sqrt(v + eps)
def _scatter_add(tgt, idx, src, axis=0):
    return tgt.clone().index_add_(axis, idx, src)
def _segment_sum(src, seg, n):
    out = torch.zeros((n,) + src.shape[1:], dtype=src.dtype)
    return out.index_add_(0, seg, src)
def _pad(x, pw):
    flat = tuple(v for pair in reversed(pw) for v in pair)
    return torch.nn.functional.pad(x, flat)

kernel_name = 'standalone__gqa_block_cached__near_ridge'

def setup_inputs():

    _w = (lambda a: (lambda t: t.to(torch.bfloat16) if t.is_floating_point() else t)(torch.as_tensor(a)))
    B, Sq, D = 8, 128, 448
    Hq, Hkv, Sk, Dh = 16, 8, 512, 256
    assert Hq % Hkv == 0, (Hq, Hkv)
    return {
        "x": _w((lambda *s: torch.randn(*s, dtype=torch.bfloat16) * 0.8)(B, Sq, D)),
        "k_cache": _w((lambda *s: torch.randn(*s, dtype=torch.bfloat16) * 0.8)(B, Hkv, Sk, Dh)),
        "v_cache": _w((lambda *s: torch.randn(*s, dtype=torch.bfloat16) * 0.05)(B, Hkv, Sk, Dh)),
        "wq": _w((lambda *s: torch.randn(*s, dtype=torch.bfloat16) * 0.8)(D, Hq * Dh) * (D ** -0.5)),
        "wo": _w((lambda *s: torch.randn(*s, dtype=torch.bfloat16) * 0.05)(Hq * Dh, D) * ((Hq * Dh) ** -0.5)),
    }

def reference(x, k_cache, v_cache, wq, wo):
    B, Sq, D = x.shape
    Hq, Dh = 16, 256
    Hkv = k_cache.shape[1]
    rep = Hq // Hkv
    q = (lambda x, *d: x.permute(*d))((x @ wq).reshape(B, Sq, Hq, Dh), 0, 2, 1, 3)
    k = (lambda x, n, axis: torch.repeat_interleave(x, n, dim=axis))(k_cache, rep, axis=1)
    v = (lambda x, n, axis: torch.repeat_interleave(x, n, dim=axis))(v_cache, rep, axis=1)
    scores = torch.einsum("bhqd,bhkd->bhqk", q, k) * (Dh ** -0.5)
    p = _softmax(scores, axis=-1)
    o = torch.einsum("bhqk,bhkd->bhqd", p, v)
    return (lambda x, *d: x.permute(*d))(o, 0, 2, 1, 3).reshape(B, Sq, Hq * Dh) @ wo
```

```asm
; @launch kernel=k1_kernel grid=(256,1,1) block=(512,1,1) lds=163840
; @launch kernel=k2_kernel grid=(224,1,1) block=(256,1,1) lds=0
.amdgcn_target "amdgcn-amd-amdhsa--gfx950"
.text
.globl k1_kernel
.p2align 8
.type k1_kernel,@function
k1_kernel:
    s_cmp_ge_u32 s2, 256
    s_cbranch_scc1 K1_EXIT
    s_load_dwordx16 s[4:19], s[0:1], 0
    s_getpc_b64 s[76:77]
    s_and_b32 s76, s76, 0xffffff00
    s_mov_b32 s78, K_ALL_END-k1_kernel
    s_mov_b32 s79, 0x00020000
    v_lshlrev_b32 v62, 7, v0
    buffer_load_dword v63, v62, s[76:79], 0 offen
    v_lshrrev_b32 v1, 6, v0
    v_and_b32 v0, 63, v0
    v_readfirstlane_b32 s3, v1
    s_and_b32 s47, s2, 7
    s_bfe_u32 s50, s2, 0x10004
    s_lshl_b32 s44, s47, 1
    s_add_u32 s44, s44, s50
    s_lshr_b32 s45, s2, 5
    s_bfe_u32 s46, s2, 0x10003
    s_lshl_b32 s56, s45, 1
    s_add_u32 s56, s56, s46
    s_cmp_lt_u32 s3, 4
    s_cbranch_scc1 K1_COMPUTE
K1_LOADER:
    s_sub_u32 s3, s3, 4
    v_lshrrev_b32 v1, 3, v0
    v_and_b32 v2, 7, v0
    v_bfe_u32 v3, v0, 4, 1
    v_lshlrev_b32 v3, 1, v3
    v_xor_b32 v3, v2, v3
    s_lshl_b32 s50, s3, 7
    v_lshl_add_u32 v3, v3, 4, s50
    v_lshl_add_u32 v16, v1, 13, v3
    v_xor_b32 v22, 64, v16
    s_lshl_b32 s62, s3, 12
    v_lshrrev_b32 v4, 4, v0
    v_xor_b32 v5, v2, v4
    s_lshl_b32 s50, s3, 4
    v_add_u32 v4, s50, v1
    v_mul_u32_u24 v4, 896, v4
    v_lshl_add_u32 v17, v5, 4, v4
    v_xor_b32 v21, 64, v17
    v_add_u32 v21, 7168, v21
    s_lshl_b32 s63, s3, 11
    s_mul_i32 s50, s56, 57344
    s_lshl_b32 s52, s44, 9
    s_mov_b32 s34, 0x37e200
    s_mov_b32 s35, 0x00020000
    s_mov_b32 s22, 57344
    s_mov_b32 s23, s35
    s_mov_b32 s66, 0x10000
    s_waitcnt lgkmcnt(0)
    s_add_u32 s32, s10, s52
    s_addc_u32 s33, s11, 0
    s_add_u32 s20, s4, s50
    s_addc_u32 s21, s5, 0
    s_add_u32 m0, s63, 0
    s_nop 0
    buffer_load_dwordx4 v17, s[20:23], 0 offen lds
    s_addk_i32 m0, 1024
    s_nop 0
    buffer_load_dwordx4 v21, s[20:23], 0 offen lds
    s_add_u32 m0, s62, 32768
    s_nop 0
    buffer_load_dwordx4 v16, s[32:35], 0 offen lds
    s_addk_i32 m0, 1024
    s_mov_b32 s54, s66
    buffer_load_dwordx4 v22, s[32:35], s54 offen lds
    s_addk_i32 m0, 1024
    s_add_u32 s54, s54, s66
    buffer_load_dwordx4 v16, s[32:35], s54 offen lds
    s_addk_i32 m0, 1024
    s_add_u32 s54, s54, s66
    buffer_load_dwordx4 v22, s[32:35], s54 offen lds
    s_lshl_b32 s50, s3, 4
    v_add_u32 v9, s50, v0
    v_lshlrev_b32 v7, 4, v9
    v_add_u32 v7, s56, v7
    v_lshrrev_b32 v4, 2, v7
    v_lshlrev_b32 v4, 13, v4
    v_and_b32 v38, 3, v7
    v_lshl_add_u32 v38, v38, 7, v4
    v_add_u32 v32, 0x200000, v38
    v_lshlrev_b32 v8, 7, v9
    s_and_b32 s50, s44, 1
    s_mul_i32 s50, s50, 28672
    v_add_u32 v40, s50, v8
    v_add_u32 v41, 8192, v40
    v_add_u32 v42, 16384, v40
    v_add_u32 v43, 24576, v40
    s_mov_b64 exec, 0xffff
    buffer_load_dword v36, v38, s[32:35], 0 offen
    buffer_load_dword v36, v32, s[32:35], 0 offen
    s_mov_b64 exec, -1
    s_lshl_b32 s51, s45, 3
    s_add_u32 s51, s51, s47
    s_lshl_b32 s51, s51, 18
    s_mul_i32 s53, s44, 229376
    s_add_u32 s24, s6, s51
    s_addc_u32 s25, s7, 0
    s_mov_b32 s26, 0x40000
    s_mov_b32 s27, 0x00020000
    s_add_u32 s28, s8, s51
    s_addc_u32 s29, s9, 0
    s_mov_b32 s30, 0x40000
    s_mov_b32 s31, 0x00020000
    s_add_u32 s36, s12, s53
    s_addc_u32 s37, s13, 0
    s_mov_b32 s38, 0x38000
    s_mov_b32 s39, 0x00020000
    s_add_u32 m0, s63, 8192
    s_mov_b32 s54, 0x80
    buffer_load_dwordx4 v17, s[20:23], s54 offen lds
    s_addk_i32 m0, 1024
    s_nop 0
    buffer_load_dwordx4 v21, s[20:23], s54 offen lds
    s_add_u32 m0, s62, 49152
    s_mov_b32 s54, 0x40000
    buffer_load_dwordx4 v16, s[32:35], s54 offen lds
    s_addk_i32 m0, 1024
    s_add_u32 s54, s54, s66
    buffer_load_dwordx4 v22, s[32:35], s54 offen lds
    s_addk_i32 m0, 1024
    s_add_u32 s54, s54, s66
    buffer_load_dwordx4 v16, s[32:35], s54 offen lds
    s_addk_i32 m0, 1024
    s_add_u32 s54, s54, s66
    buffer_load_dwordx4 v22, s[32:35], s54 offen lds
    s_add_u32 m0, s63, 16384
    s_mov_b32 s54, 0x100
    buffer_load_dwordx4 v17, s[20:23], s54 offen lds
    s_addk_i32 m0, 1024
    s_nop 0
    buffer_load_dwordx4 v21, s[20:23], s54 offen lds
    s_addk_i32 m0, 7168
    s_addk_i32 s54, 128
    buffer_load_dwordx4 v17, s[20:23], s54 offen lds
    s_addk_i32 m0, 1024
    s_nop 0
    buffer_load_dwordx4 v21, s[20:23], s54 offen lds
    s_add_u32 m0, s62, 65536
    s_mov_b32 s54, 0x80000
    buffer_load_dwordx4 v16, s[32:35], s54 offen lds
    s_addk_i32 m0, 1024
    s_add_u32 s54, s54, s66
    buffer_load_dwordx4 v22, s[32:35], s54 offen lds
    s_addk_i32 m0, 1024
    s_add_u32 s54, s54, s66
    buffer_load_dwordx4 v16, s[32:35], s54 offen lds
    s_addk_i32 m0, 1024
    s_add_u32 s54, s54, s66
    buffer_load_dwordx4 v22, s[32:35], s54 offen lds
    s_bfe_u32 s50, s2, 0x20003
    s_lshl_b32 s65, s50, 1
    s_and_b32 s52, s45, 1
    s_add_u32 s65, s65, s52
    s_lshl_b32 s51, s50, 14
    v_add_u32 v33, s51, v8
    v_mov_b32 v34, v33
    v_mov_b32 v44, 0
    s_cmp_lg_u32 s65, 0
    s_cbranch_scc1 BURST_1001
    s_mov_b64 exec, 0xffff
    buffer_load_dword v36, v33, s[24:27], 0 offen
    s_mov_b32 s53, 0x2000
    buffer_load_dword v36, v33, s[24:27], s53 offen
    s_mov_b32 s53, 0x10000
    buffer_load_dword v36, v33, s[24:27], s53 offen
    s_mov_b32 s53, 0x12000
    buffer_load_dword v36, v33, s[24:27], s53 offen
    s_mov_b32 s53, 0x20000
    buffer_load_dword v36, v33, s[24:27], s53 offen
    s_mov_b32 s53, 0x22000
    buffer_load_dword v36, v33, s[24:27], s53 offen
    s_mov_b32 s53, 0x30000
    buffer_load_dword v36, v33, s[24:27], s53 offen
    s_mov_b32 s53, 0x32000
    buffer_load_dword v36, v33, s[24:27], s53 offen
    s_mov_b64 exec, -1
BURST_1001:
    s_waitcnt vmcnt(16)
    s_barrier
    s_cmp_lg_u32 s65, 1
    s_cbranch_scc1 BURST_1002
    s_mov_b64 exec, 0xffff
    buffer_load_dword v36, v33, s[24:27], 0 offen
    s_mov_b32 s53, 0x2000
    buffer_load_dword v36, v33, s[24:27], s53 offen
    s_mov_b32 s53, 0x10000
    buffer_load_dword v36, v33, s[24:27], s53 offen
    s_mov_b32 s53, 0x12000
    buffer_load_dword v36, v33, s[24:27], s53 offen
    s_mov_b32 s53, 0x20000
    buffer_load_dword v36, v33, s[24:27], s53 offen
    s_mov_b32 s53, 0x22000
    buffer_load_dword v36, v33, s[24:27], s53 offen
    s_mov_b32 s53, 0x30000
    buffer_load_dword v36, v33, s[24:27], s53 offen
    s_mov_b32 s53, 0x32000
    buffer_load_dword v36, v33, s[24:27], s53 offen
    s_mov_b64 exec, -1
BURST_1002:
    s_add_u32 m0, s63, 131072
    s_mov_b32 s54, 0x200
    buffer_load_dwordx4 v17, s[20:23], s54 offen lds
    s_addk_i32 m0, 1024
    s_nop 0
    buffer_load_dwordx4 v21, s[20:23], s54 offen lds
    s_addk_i32 m0, 7168
    s_addk_i32 s54, 128
    buffer_load_dwordx4 v17, s[20:23], s54 offen lds
    s_addk_i32 m0, 1024
    s_nop 0
    buffer_load_dwordx4 v21, s[20:23], s54 offen lds
    s_add_u32 m0, s62, 81920
    s_mov_b32 s54, 0xc0000
    buffer_load_dwordx4 v16, s[32:35], s54 offen lds
    s_addk_i32 m0, 1024
    s_add_u32 s54, s54, s66
    buffer_load_dwordx4 v22, s[32:35], s54 offen lds
    s_addk_i32 m0, 1024
    s_add_u32 s54, s54, s66
    buffer_load_dwordx4 v16, s[32:35], s54 offen lds
    s_addk_i32 m0, 1024
    s_add_u32 s54, s54, s66
    buffer_load_dwordx4 v22, s[32:35], s54 offen lds
    s_add_u32 m0, s63, 147456
    s_mov_b32 s54, 0x300
    buffer_load_dwordx4 v17, s[20:23], s54 offen lds
    s_addk_i32 m0, 1024
    s_nop 0
    buffer_load_dwordx4 v21, s[20:23], s54 offen lds
    s_add_u32 m0, s62, 98304
    s_mov_b32 s54, 0x100000
    buffer_load_dwordx4 v16, s[32:35], s54 offen lds
    s_addk_i32 m0, 1024
    s_add_u32 s54, s54, s66
    buffer_load_dwordx4 v22, s[32:35], s54 offen lds
    s_waitcnt vmcnt(20)
    s_barrier
    s_addk_i32 m0, 1024
    s_add_u32 s54, s54, s66
    buffer_load_dwordx4 v16, s[32:35], s54 offen lds
    s_addk_i32 m0, 1024
    s_add_u32 s54, s54, s66
    buffer_load_dwordx4 v22, s[32:35], s54 offen lds
    s_addk_i32 m0, 13312
    s_add_u32 s54, s54, s66
    buffer_load_dwordx4 v16, s[32:35], s54 offen lds
    s_addk_i32 m0, 1024
    s_add_u32 s54, s54, s66
    buffer_load_dwordx4 v22, s[32:35], s54 offen lds
    s_addk_i32 m0, 1024
    s_add_u32 s54, s54, s66
    buffer_load_dwordx4 v16, s[32:35], s54 offen lds
    s_addk_i32 m0, 1024
    s_add_u32 s54, s54, s66
    buffer_load_dwordx4 v22, s[32:35], s54 offen lds
    s_waitcnt vmcnt(18)
    s_barrier
    v_lshrrev_b32 v4, 4, v0
    v_xor_b32 v5, v2, v4
    v_lshlrev_b32 v5, 4, v5
    s_lshl_b32 s50, s3, 16
    v_add_u32 v5, s50, v5
    v_lshl_add_u32 v18, v1, 9, v5
    v_xor_b32 v19, 64, v18
    v_bfe_u32 v5, v0, 4, 2
    v_lshlrev_b32 v5, 1, v5
    v_xor_b32 v5, v2, v5
    v_lshlrev_b32 v5, 4, v5
    s_lshl_b32 s50, s3, 7
    v_add_u32 v6, s50, v5
    v_lshl_add_u32 v20, v1, 9, v6
    s_lshl_b32 s50, s3, 5
    v_add_u32 v4, s50, v1
    v_mul_u32_u24 v4, 896, v4
    v_add_u32 v24, v5, v4
    s_mul_i32 s51, s56, 14336
    v_add_u32 v35, s51, v8
    v_add_u32 v37, 0x2000, v35
    s_add_u32 m0, s62, 32768
    s_add_u32 s54, s54, s66
    buffer_load_dwordx4 v16, s[32:35], s54 offen lds
    s_addk_i32 m0, 1024
    s_add_u32 s54, s54, s66
    buffer_load_dwordx4 v22, s[32:35], s54 offen lds
    s_addk_i32 m0, 1024
    s_add_u32 s54, s54, s66
    buffer_load_dwordx4 v16, s[32:35], s54 offen lds
    s_addk_i32 m0, 1024
    s_add_u32 s54, s54, s66
    buffer_load_dwordx4 v22, s[32:35], s54 offen lds
    s_waitcnt vmcnt(14)
    s_barrier
    s_cmp_lg_u32 s65, 2
    s_cbranch_scc1 BURST_1003
    s_mov_b64 exec, 0xffff
    buffer_load_dword v36, v33, s[24:27], 0 offen
    s_mov_b32 s53, 0x2000
    buffer_load_dword v36, v33, s[24:27], s53 offen
    s_mov_b32 s53, 0x10000
    buffer_load_dword v36, v33, s[24:27], s53 offen
    s_mov_b32 s53, 0x12000
    buffer_load_dword v36, v33, s[24:27], s53 offen
    s_mov_b32 s53, 0x20000
    buffer_load_dword v36, v33, s[24:27], s53 offen
    s_mov_b32 s53, 0x22000
    buffer_load_dword v36, v33, s[24:27], s53 offen
    s_mov_b32 s53, 0x30000
    buffer_load_dword v36, v33, s[24:27], s53 offen
    s_mov_b32 s53, 0x32000
    buffer_load_dword v36, v33, s[24:27], s53 offen
    s_mov_b64 exec, -1
BURST_1003:
    s_addk_i32 m0, 13312
    s_add_u32 s54, s54, s66
    buffer_load_dwordx4 v16, s[32:35], s54 offen lds
    s_addk_i32 m0, 1024
    s_add_u32 s54, s54, s66
    buffer_load_dwordx4 v22, s[32:35], s54 offen lds
    s_addk_i32 m0, 1024
    s_add_u32 s54, s54, s66
    buffer_load_dwordx4 v16, s[32:35], s54 offen lds
    s_addk_i32 m0, 1024
    s_add_u32 s54, s54, s66
    buffer_load_dwordx4 v22, s[32:35], s54 offen lds
    s_waitcnt vmcnt(12)
    s_barrier
    s_addk_i32 m0, 13312
    s_add_u32 s54, s54, s66
    buffer_load_dwordx4 v16, s[32:35], s54 offen lds
    s_addk_i32 m0, 1024
    s_add_u32 s54, s54, s66
    buffer_load_dwordx4 v22, s[32:35], s54 offen lds
    s_addk_i32 m0, 1024
    s_add_u32 s54, s54, s66
    buffer_load_dwordx4 v16, s[32:35], s54 offen lds
    s_addk_i32 m0, 1024
    s_add_u32 s54, s54, s66
    buffer_load_dwordx4 v22, s[32:35], s54 offen lds
    s_waitcnt vmcnt(12)
    s_barrier
    s_addk_i32 m0, 13312
    s_add_u32 s54, s54, s66
    buffer_load_dwordx4 v16, s[32:35], s54 offen lds
    s_addk_i32 m0, 1024
    s_add_u32 s54, s54, s66
    buffer_load_dwordx4 v22, s[32:35], s54 offen lds
    s_addk_i32 m0, 1024
    s_add_u32 s54, s54, s66
    buffer_load_dwordx4 v16, s[32:35], s54 offen lds
    s_addk_i32 m0, 1024
    s_add_u32 s54, s54, s66
    buffer_load_dwordx4 v22, s[32:35], s54 offen lds
    s_waitcnt vmcnt(12)
    s_barrier
    s_cmp_lg_u32 s65, 3
    s_cbranch_scc1 BURST_1004
    s_mov_b64 exec, 0xffff
    buffer_load_dword v36, v33, s[24:27], 0 offen
    s_mov_b32 s53, 0x2000
    buffer_load_dword v36, v33, s[24:27], s53 offen
    s_mov_b32 s53, 0x10000
    buffer_load_dword v36, v33, s[24:27], s53 offen
    s_mov_b32 s53, 0x12000
    buffer_load_dword v36, v33, s[24:27], s53 offen
    s_mov_b32 s53, 0x20000
    buffer_load_dword v36, v33, s[24:27], s53 offen
    s_mov_b32 s53, 0x22000
    buffer_load_dword v36, v33, s[24:27], s53 offen
    s_mov_b32 s53, 0x30000
    buffer_load_dword v36, v33, s[24:27], s53 offen
    s_mov_b32 s53, 0x32000
    buffer_load_dword v36, v33, s[24:27], s53 offen
    s_mov_b64 exec, -1
BURST_1004:
    s_addk_i32 m0, 13312
    s_add_u32 s54, s54, s66
    buffer_load_dwordx4 v16, s[32:35], s54 offen lds
    s_addk_i32 m0, 1024
    s_add_u32 s54, s54, s66
    buffer_load_dwordx4 v22, s[32:35], s54 offen lds
    s_addk_i32 m0, 1024
    s_add_u32 s54, s54, s66
    buffer_load_dwordx4 v16, s[32:35], s54 offen lds
    s_addk_i32 m0, 1024
    s_add_u32 s54, s54, s66
    buffer_load_dwordx4 v22, s[32:35], s54 offen lds
    s_waitcnt vmcnt(12)
    s_barrier
    s_addk_i32 m0, 13312
    s_add_u32 s54, s54, s66
    buffer_load_dwordx4 v16, s[32:35], s54 offen lds
    s_addk_i32 m0, 1024
    s_add_u32 s54, s54, s66
    buffer_load_dwordx4 v22, s[32:35], s54 offen lds
    s_addk_i32 m0, 1024
    s_add_u32 s54, s54, s66
    buffer_load_dwordx4 v16, s[32:35], s54 offen lds
    s_addk_i32 m0, 1024
    s_add_u32 s54, s54, s66
    buffer_load_dwordx4 v22, s[32:35], s54 offen lds
    s_waitcnt vmcnt(12)
    s_barrier
    s_add_u32 m0, s62, 32768
    s_add_u32 s54, s54, s66
    buffer_load_dwordx4 v16, s[32:35], s54 offen lds
    s_addk_i32 m0, 1024
    s_add_u32 s54, s54, s66
    buffer_load_dwordx4 v22, s[32:35], s54 offen lds
    s_addk_i32 m0, 1024
    s_add_u32 s54, s54, s66
    buffer_load_dwordx4 v16, s[32:35], s54 offen lds
    s_addk_i32 m0, 1024
    s_add_u32 s54, s54, s66
    buffer_load_dwordx4 v22, s[32:35], s54 offen lds
    s_waitcnt vmcnt(12)
    s_barrier
    s_cmp_lg_u32 s65, 4
    s_cbranch_scc1 BURST_1005
    s_mov_b64 exec, 0xffff
    buffer_load_dword v36, v33, s[24:27], 0 offen
    s_mov_b32 s53, 0x2000
    buffer_load_dword v36, v33, s[24:27], s53 offen
    s_mov_b32 s53, 0x10000
    buffer_load_dword v36, v33, s[24:27], s53 offen
    s_mov_b32 s53, 0x12000
    buffer_load_dword v36, v33, s[24:27], s53 offen
    s_mov_b32 s53, 0x20000
    buffer_load_dword v36, v33, s[24:27], s53 offen
    s_mov_b32 s53, 0x22000
    buffer_load_dword v36, v33, s[24:27], s53 offen
    s_mov_b32 s53, 0x30000
    buffer_load_dword v36, v33, s[24:27], s53 offen
    s_mov_b32 s53, 0x32000
    buffer_load_dword v36, v33, s[24:27], s53 offen
    s_mov_b64 exec, -1
BURST_1005:
    s_addk_i32 m0, 13312
    s_add_u32 s54, s54, s66
    buffer_load_dwordx4 v16, s[32:35], s54 offen lds
    s_addk_i32 m0, 1024
    s_add_u32 s54, s54, s66
    buffer_load_dwordx4 v22, s[32:35], s54 offen lds
    s_addk_i32 m0, 1024
    s_add_u32 s54, s54, s66
    buffer_load_dwordx4 v16, s[32:35], s54 offen lds
    s_addk_i32 m0, 1024
    s_add_u32 s54, s54, s66
    buffer_load_dwordx4 v22, s[32:35], s54 offen lds
    s_waitcnt vmcnt(12)
    s_barrier
    s_addk_i32 m0, 13312
    s_nop 0
    buffer_load_dwordx4 v18, s[24:27], 0 offen lds
    s_addk_i32 m0, 1024
    s_mov_b32 s54, 0x1000
    buffer_load_dwordx4 v19, s[24:27], s54 offen lds
    s_addk_i32 m0, 1024
    s_addk_i32 s54, 4096
    buffer_load_dwordx4 v18, s[24:27], s54 offen lds
    s_addk_i32 m0, 1024
    s_addk_i32 s54, 4096
    buffer_load_dwordx4 v19, s[24:27], s54 offen lds
    s_waitcnt vmcnt(12)
    s_barrier
    s_cmp_lg_u32 s65, 5
    s_cbranch_scc1 BURST_1006
    s_mov_b64 exec, 0xffff
    buffer_load_dword v36, v33, s[24:27], 0 offen
    s_mov_b32 s53, 0x2000
    buffer_load_dword v36, v33, s[24:27], s53 offen
    s_mov_b32 s53, 0x10000
    buffer_load_dword v36, v33, s[24:27], s53 offen
    s_mov_b32 s53, 0x12000
    buffer_load_dword v36, v33, s[24:27], s53 offen
    s_mov_b32 s53, 0x20000
    buffer_load_dword v36, v33, s[24:27], s53 offen
    s_mov_b32 s53, 0x22000
    buffer_load_dword v36, v33, s[24:27], s53 offen
    s_mov_b32 s53, 0x30000
    buffer_load_dword v36, v33, s[24:27], s53 offen
    s_mov_b32 s53, 0x32000
    buffer_load_dword v36, v33, s[24:27], s53 offen
    s_mov_b64 exec, -1
BURST_1006:
    s_addk_i32 m0, 13312
    s_addk_i32 s54, 4096
    buffer_load_dwordx4 v18, s[24:27], s54 offen lds
    s_addk_i32 m0, 1024
    s_addk_i32 s54, 4096
    buffer_load_dwordx4 v19, s[24:27], s54 offen lds
    s_addk_i32 m0, 1024
    s_addk_i32 s54, 4096
    buffer_load_dwordx4 v18, s[24:27], s54 offen lds
    s_addk_i32 m0, 1024
    s_addk_i32 s54, 4096
    buffer_load_dwordx4 v19, s[24:27], s54 offen lds
    s_waitcnt vmcnt(12)
    s_barrier
    s_addk_i32 m0, 13312
    s_addk_i32 s54, -28544
    buffer_load_dwordx4 v18, s[24:27], s54 offen lds
    s_addk_i32 m0, 1024
    s_addk_i32 s54, 4096
    buffer_load_dwordx4 v19, s[24:27], s54 offen lds
    s_addk_i32 m0, 1024
    s_addk_i32 s54, 4096
    buffer_load_dwordx4 v18, s[24:27], s54 offen lds
    s_addk_i32 m0, 1024
    s_addk_i32 s54, 4096
    buffer_load_dwordx4 v19, s[24:27], s54 offen lds
    s_waitcnt vmcnt(12)
    s_barrier
    s_waitcnt vmcnt(8)
    s_barrier
    s_barrier
    s_cmp_lg_u32 s65, 6
    s_cbranch_scc1 BURST_1007
    s_mov_b64 exec, 0xffff
    buffer_load_dword v36, v33, s[24:27], 0 offen
    s_mov_b32 s53, 0x2000
    buffer_load_dword v36, v33, s[24:27], s53 offen
    s_mov_b32 s53, 0x10000
    buffer_load_dword v36, v33, s[24:27], s53 offen
    s_mov_b32 s53, 0x12000
    buffer_load_dword v36, v33, s[24:27], s53 offen
    s_mov_b32 s53, 0x20000
    buffer_load_dword v36, v33, s[24:27], s53 offen
    s_mov_b32 s53, 0x22000
    buffer_load_dword v36, v33, s[24:27], s53 offen
    s_mov_b32 s53, 0x30000
    buffer_load_dword v36, v33, s[24:27], s53 offen
    s_mov_b32 s53, 0x32000
    buffer_load_dword v36, v33, s[24:27], s53 offen
    s_mov_b64 exec, -1
BURST_1007:
    s_addk_i32 m0, 13312
    s_addk_i32 s54, 4096
    buffer_load_dwordx4 v18, s[24:27], s54 offen lds
    s_addk_i32 m0, 1024
    s_addk_i32 s54, 4096
    buffer_load_dwordx4 v19, s[24:27], s54 offen lds
    s_addk_i32 m0, 1024
    s_addk_i32 s54, 4096
    buffer_load_dwordx4 v18, s[24:27], s54 offen lds
    s_addk_i32 m0, 1024
    s_addk_i32 s54, 4096
    buffer_load_dwordx4 v19, s[24:27], s54 offen lds
    s_add_u32 m0, s62, 32768
    s_addk_i32 s54, -28544
    buffer_load_dwordx4 v18, s[24:27], s54 offen lds
    s_waitcnt vmcnt(9)
    s_barrier
    s_addk_i32 m0, 1024
    s_addk_i32 s54, 4096
    buffer_load_dwordx4 v19, s[24:27], s54 offen lds
    s_addk_i32 m0, 1024
    s_addk_i32 s54, 4096
    buffer_load_dwordx4 v18, s[24:27], s54 offen lds
    s_addk_i32 m0, 1024
    s_addk_i32 s54, 4096
    buffer_load_dwordx4 v19, s[24:27], s54 offen lds
    s_addk_i32 m0, 13312
    s_addk_i32 s54, 4096
    buffer_load_dwordx4 v18, s[24:27], s54 offen lds
    s_addk_i32 m0, 1024
    s_addk_i32 s54, 4096
    buffer_load_dwordx4 v19, s[24:27], s54 offen lds
    s_waitcnt vmcnt(10)
    s_barrier
    s_cmp_lg_u32 s65, 7
    s_cbranch_scc1 BURST_1008
    s_mov_b64 exec, 0xffff
    buffer_load_dword v36, v33, s[24:27], 0 offen
    s_mov_b32 s53, 0x2000
    buffer_load_dword v36, v33, s[24:27], s53 offen
    s_mov_b32 s53, 0x10000
    buffer_load_dword v36, v33, s[24:27], s53 offen
    s_mov_b32 s53, 0x12000
    buffer_load_dword v36, v33, s[24:27], s53 offen
    s_mov_b32 s53, 0x20000
    buffer_load_dword v36, v33, s[24:27], s53 offen
    s_mov_b32 s53, 0x22000
    buffer_load_dword v36, v33, s[24:27], s53 offen
    s_mov_b32 s53, 0x30000
    buffer_load_dword v36, v33, s[24:27], s53 offen
    s_mov_b32 s53, 0x32000
    buffer_load_dword v36, v33, s[24:27], s53 offen
    s_mov_b64 exec, -1
BURST_1008:
    s_addk_i32 m0, 1024
    s_addk_i32 s54, 4096
    buffer_load_dwordx4 v18, s[24:27], s54 offen lds
    s_addk_i32 m0, 1024
    s_addk_i32 s54, 4096
    buffer_load_dwordx4 v19, s[24:27], s54 offen lds
    s_add_u32 m0, s62, 131072
    s_addk_i32 s54, -28544
    buffer_load_dwordx4 v18, s[24:27], s54 offen lds
    s_addk_i32 m0, 1024
    s_addk_i32 s54, 4096
    buffer_load_dwordx4 v19, s[24:27], s54 offen lds
    s_addk_i32 m0, 1024
    s_addk_i32 s54, 4096
    buffer_load_dwordx4 v18, s[24:27], s54 offen lds
    s_waitcnt vmcnt(11)
    s_barrier
    s_addk_i32 m0, 1024
    s_addk_i32 s54, 4096
    buffer_load_dwordx4 v19, s[24:27], s54 offen lds
    s_addk_i32 m0, 13312
    s_addk_i32 s54, 4096
    buffer_load_dwordx4 v18, s[24:27], s54 offen lds
    s_addk_i32 m0, 1024
    s_addk_i32 s54, 4096
    buffer_load_dwordx4 v19, s[24:27], s54 offen lds
    s_addk_i32 m0, 1024
    s_addk_i32 s54, 4096
    buffer_load_dwordx4 v18, s[24:27], s54 offen lds
    s_addk_i32 m0, 1024
    s_addk_i32 s54, 4096
    buffer_load_dwordx4 v19, s[24:27], s54 offen lds
    s_waitcnt vmcnt(12)
    s_barrier
    s_add_u32 m0, s62, 65536
    s_addk_i32 s54, 3712
    buffer_load_dwordx4 v18, s[24:27], s54 offen lds
    s_addk_i32 m0, 1024
    s_addk_i32 s54, 4096
    buffer_load_dwordx4 v19, s[24:27], s54 offen lds
    s_addk_i32 m0, 1024
    s_addk_i32 s54, 4096
    buffer_load_dwordx4 v18, s[24:27], s54 offen lds
    s_addk_i32 m0, 1024
    s_addk_i32 s54, 4096
    buffer_load_dwordx4 v19, s[24:27], s54 offen lds
    s_waitcnt vmcnt(12)
    s_barrier
    s_addk_i32 m0, 13312
    s_addk_i32 s54, 4096
    buffer_load_dwordx4 v18, s[24:27], s54 offen lds
    s_addk_i32 m0, 1024
    s_addk_i32 s54, 4096
    buffer_load_dwordx4 v19, s[24:27], s54 offen lds
    s_addk_i32 m0, 1024
    s_addk_i32 s54, 4096
    buffer_load_dwordx4 v18, s[24:27], s54 offen lds
    s_addk_i32 m0, 1024
    s_addk_i32 s54, 4096
    buffer_load_dwordx4 v19, s[24:27], s54 offen lds
    s_waitcnt vmcnt(12)
    s_barrier
    s_addk_i32 m0, 13312
    s_addk_i32 s54, -28544
    buffer_load_dwordx4 v18, s[24:27], s54 offen lds
    s_addk_i32 m0, 1024
    s_addk_i32 s54, 4096
    buffer_load_dwordx4 v19, s[24:27], s54 offen lds
    s_addk_i32 m0, 1024
    s_addk_i32 s54, 4096
    buffer_load_dwordx4 v18, s[24:27], s54 offen lds
    s_addk_i32 m0, 1024
    s_addk_i32 s54, 4096
    buffer_load_dwordx4 v19, s[24:27], s54 offen lds
    s_waitcnt vmcnt(12)
    s_barrier
    s_addk_i32 m0, 13312
    s_addk_i32 s54, 4096
    buffer_load_dwordx4 v18, s[24:27], s54 offen lds
    s_addk_i32 m0, 1024
    s_addk_i32 s54, 4096
    buffer_load_dwordx4 v19, s[24:27], s54 offen lds
    s_addk_i32 m0, 1024
    s_addk_i32 s54, 4096
    buffer_load_dwordx4 v18, s[24:27], s54 offen lds
    s_addk_i32 m0, 1024
    s_addk_i32 s54, 4096
    buffer_load_dwordx4 v19, s[24:27], s54 offen lds
    s_waitcnt vmcnt(12)
    s_barrier
    s_add_u32 m0, s62, 32768
    s_addk_i32 s54, -28544
    buffer_load_dwordx4 v18, s[24:27], s54 offen lds
    s_addk_i32 m0, 1024
    s_addk_i32 s54, 4096
    buffer_load_dwordx4 v19, s[24:27], s54 offen lds
    s_addk_i32 m0, 1024
    s_addk_i32 s54, 4096
    buffer_load_dwordx4 v18, s[24:27], s54 offen lds
    s_addk_i32 m0, 1024
    s_addk_i32 s54, 4096
    buffer_load_dwordx4 v19, s[24:27], s54 offen lds
    s_waitcnt vmcnt(12)
    s_barrier
    s_addk_i32 m0, 13312
    s_addk_i32 s54, 4096
    buffer_load_dwordx4 v18, s[24:27], s54 offen lds
    s_addk_i32 m0, 1024
    s_addk_i32 s54, 4096
    buffer_load_dwordx4 v19, s[24:27], s54 offen lds
    s_addk_i32 m0, 1024
    s_addk_i32 s54, 4096
    buffer_load_dwordx4 v18, s[24:27], s54 offen lds
    s_addk_i32 m0, 1024
    s_addk_i32 s54, 4096
    buffer_load_dwordx4 v19, s[24:27], s54 offen lds
    s_waitcnt vmcnt(12)
    s_barrier
    s_add_u32 m0, s62, 131072
    s_addk_i32 s54, -28544
    buffer_load_dwordx4 v18, s[24:27], s54 offen lds
    s_addk_i32 m0, 1024
    s_addk_i32 s54, 4096
    buffer_load_dwordx4 v19, s[24:27], s54 offen lds
    s_addk_i32 m0, 1024
    s_addk_i32 s54, 4096
    buffer_load_dwordx4 v18, s[24:27], s54 offen lds
    s_addk_i32 m0, 1024
    s_addk_i32 s54, 4096
    buffer_load_dwordx4 v19, s[24:27], s54 offen lds
    s_waitcnt vmcnt(12)
    s_barrier
    s_addk_i32 m0, 13312
    s_addk_i32 s54, 4096
    buffer_load_dwordx4 v18, s[24:27], s54 offen lds
    s_addk_i32 m0, 1024
    s_addk_i32 s54, 4096
    buffer_load_dwordx4 v19, s[24:27], s54 offen lds
    s_addk_i32 m0, 1024
    s_addk_i32 s54, 4096
    buffer_load_dwordx4 v18, s[24:27], s54 offen lds
    s_addk_i32 m0, 1024
    s_addk_i32 s54, 4096
    buffer_load_dwordx4 v19, s[24:27], s54 offen lds
    s_waitcnt vmcnt(12)
    s_barrier
    s_add_u32 m0, s62, 65536
    s_nop 0
    buffer_load_dwordx4 v20, s[28:31], 0 offen lds
    s_addk_i32 m0, 1024
    s_mov_b32 s54, 0x1000
    buffer_load_dwordx4 v20, s[28:31], s54 offen lds
    s_addk_i32 m0, 1024
    s_addk_i32 s54, 4096
    buffer_load_dwordx4 v20, s[28:31], s54 offen lds
    s_addk_i32 m0, 1024
    s_addk_i32 s54, 4096
    buffer_load_dwordx4 v20, s[28:31], s54 offen lds
    s_waitcnt vmcnt(12)
    s_barrier
    s_addk_i32 m0, 13312
    s_mov_b32 s54, s66
    buffer_load_dwordx4 v20, s[28:31], s54 offen lds
    s_addk_i32 m0, 1024
    s_addk_i32 s54, 4096
    buffer_load_dwordx4 v20, s[28:31], s54 offen lds
    s_addk_i32 m0, 1024
    s_addk_i32 s54, 4096
    buffer_load_dwordx4 v20, s[28:31], s54 offen lds
    s_addk_i32 m0, 1024
    s_addk_i32 s54, 4096
    buffer_load_dwordx4 v20, s[28:31], s54 offen lds
    s_waitcnt vmcnt(12)
    s_barrier
    s_addk_i32 m0, 13312
    s_mov_b32 s54, 0x20000
    buffer_load_dwordx4 v20, s[28:31], s54 offen lds
    s_addk_i32 m0, 1024
    s_addk_i32 s54, 4096
    buffer_load_dwordx4 v20, s[28:31], s54 offen lds
    s_addk_i32 m0, 1024
    s_addk_i32 s54, 4096
    buffer_load_dwordx4 v20, s[28:31], s54 offen lds
    s_addk_i32 m0, 1024
    s_addk_i32 s54, 4096
    buffer_load_dwordx4 v20, s[28:31], s54 offen lds
    s_waitcnt vmcnt(12)
    s_barrier
    s_addk_i32 m0, 13312
    s_mov_b32 s54, 0x30000
    buffer_load_dwordx4 v20, s[28:31], s54 offen lds
    s_addk_i32 m0, 1024
    s_addk_i32 s54, 4096
    buffer_load_dwordx4 v20, s[28:31], s54 offen lds
    s_addk_i32 m0, 1024
    s_addk_i32 s54, 4096
    buffer_load_dwordx4 v20, s[28:31], s54 offen lds
    s_addk_i32 m0, 1024
    s_addk_i32 s54, 4096
    buffer_load_dwordx4 v20, s[28:31], s54 offen lds
    s_waitcnt vmcnt(12)
    s_barrier
    s_add_u32 m0, s62, 32768
    s_mov_b32 s54, 0x4000
    buffer_load_dwordx4 v20, s[28:31], s54 offen lds
    s_addk_i32 m0, 1024
    s_addk_i32 s54, 4096
    buffer_load_dwordx4 v20, s[28:31], s54 offen lds
    s_addk_i32 m0, 1024
    s_addk_i32 s54, 4096
    buffer_load_dwordx4 v20, s[28:31], s54 offen lds
    s_addk_i32 m0, 1024
    s_addk_i32 s54, 4096
    buffer_load_dwordx4 v20, s[28:31], s54 offen lds
    s_barrier
    s_mov_b64 exec, 0xffff
    buffer_load_dword v36, v35, s[36:39], 0 offen
    buffer_load_dword v36, v37, s[36:39], 0 offen
    s_mov_b64 exec, -1
    s_addk_i32 m0, 13312
    s_mov_b32 s54, 0x14000
    buffer_load_dwordx4 v20, s[28:31], s54 offen lds
    s_addk_i32 m0, 1024
    s_addk_i32 s54, 4096
    buffer_load_dwordx4 v20, s[28:31], s54 offen lds
    s_addk_i32 m0, 1024
    s_addk_i32 s54, 4096
    buffer_load_dwordx4 v20, s[28:31], s54 offen lds
    s_addk_i32 m0, 1024
    s_addk_i32 s54, 4096
    buffer_load_dwordx4 v20, s[28:31], s54 offen lds
    s_barrier
    s_add_u32 m0, s62, 131072
    s_mov_b32 s54, 0x24000
    buffer_load_dwordx4 v20, s[28:31], s54 offen lds
    s_addk_i32 m0, 1024
    s_addk_i32 s54, 4096
    buffer_load_dwordx4 v20, s[28:31], s54 offen lds
    s_addk_i32 m0, 1024
    s_addk_i32 s54, 4096
    buffer_load_dwordx4 v20, s[28:31], s54 offen lds
    s_addk_i32 m0, 1024
    s_addk_i32 s54, 4096
    buffer_load_dwordx4 v20, s[28:31], s54 offen lds
    s_addk_i32 m0, 13312
    s_mov_b32 s54, 0x34000
    buffer_load_dwordx4 v20, s[28:31], s54 offen lds
    s_waitcnt vmcnt(23)
    s_barrier
    s_waitcnt vmcnt(19)
    s_barrier
    s_waitcnt vmcnt(15)
    s_barrier
    s_addk_i32 m0, 1024
    s_addk_i32 s54, 4096
    buffer_load_dwordx4 v20, s[28:31], s54 offen lds
    s_addk_i32 m0, 1024
    s_addk_i32 s54, 4096
    buffer_load_dwordx4 v20, s[28:31], s54 offen lds
    s_addk_i32 m0, 1024
    s_addk_i32 s54, 4096
    buffer_load_dwordx4 v20, s[28:31], s54 offen lds
    s_waitcnt vmcnt(14)
    s_barrier
    s_add_u32 m0, s62, 65536
    s_mov_b32 s54, 0x8000
    buffer_load_dwordx4 v20, s[28:31], s54 offen lds
    s_addk_i32 m0, 1024
    s_addk_i32 s54, 4096
    buffer_load_dwordx4 v20, s[28:31], s54 offen lds
    s_addk_i32 m0, 1024
    s_addk_i32 s54, 4096
    buffer_load_dwordx4 v20, s[28:31], s54 offen lds
    s_addk_i32 m0, 1024
    s_addk_i32 s54, 4096
    buffer_load_dwordx4 v20, s[28:31], s54 offen lds
    s_waitcnt vmcnt(12)
    s_barrier
    s_addk_i32 m0, 13312
    s_mov_b32 s54, 0x18000
    buffer_load_dwordx4 v20, s[28:31], s54 offen lds
    s_addk_i32 m0, 1024
    s_addk_i32 s54, 4096
    buffer_load_dwordx4 v20, s[28:31], s54 offen lds
    s_addk_i32 m0, 1024
    s_addk_i32 s54, 4096
    buffer_load_dwordx4 v20, s[28:31], s54 offen lds
    s_addk_i32 m0, 1024
    s_addk_i32 s54, 4096
    buffer_load_dwordx4 v20, s[28:31], s54 offen lds
    s_waitcnt vmcnt(12)
    s_barrier
    s_addk_i32 m0, 13312
    s_mov_b32 s54, 0x28000
    buffer_load_dwordx4 v20, s[28:31], s54 offen lds
    s_addk_i32 m0, 1024
    s_addk_i32 s54, 4096
    buffer_load_dwordx4 v20, s[28:31], s54 offen lds
    s_addk_i32 m0, 1024
    s_addk_i32 s54, 4096
    buffer_load_dwordx4 v20, s[28:31], s54 offen lds
    s_addk_i32 m0, 1024
    s_addk_i32 s54, 4096
    buffer_load_dwordx4 v20, s[28:31], s54 offen lds
    s_waitcnt vmcnt(12)
    s_barrier
    s_addk_i32 m0, 13312
    s_mov_b32 s54, 0x38000
    buffer_load_dwordx4 v20, s[28:31], s54 offen lds
    s_addk_i32 m0, 1024
    s_addk_i32 s54, 4096
    buffer_load_dwordx4 v20, s[28:31], s54 offen lds
    s_addk_i32 m0, 1024
    s_addk_i32 s54, 4096
    buffer_load_dwordx4 v20, s[28:31], s54 offen lds
    s_addk_i32 m0, 1024
    s_addk_i32 s54, 4096
    buffer_load_dwordx4 v20, s[28:31], s54 offen lds
    s_waitcnt vmcnt(12)
    s_barrier
    s_add_u32 m0, s62, 32768
    s_mov_b32 s54, 0xc000
    buffer_load_dwordx4 v20, s[28:31], s54 offen lds
    s_addk_i32 m0, 1024
    s_addk_i32 s54, 4096
    buffer_load_dwordx4 v20, s[28:31], s54 offen lds
    s_addk_i32 m0, 1024
    s_addk_i32 s54, 4096
    buffer_load_dwordx4 v20, s[28:31], s54 offen lds
    s_addk_i32 m0, 1024
    s_addk_i32 s54, 4096
    buffer_load_dwordx4 v20, s[28:31], s54 offen lds
    s_barrier
    s_waitcnt vmcnt(12)
    s_barrier
    s_addk_i32 m0, 13312
    s_mov_b32 s54, 0x1c000
    buffer_load_dwordx4 v20, s[28:31], s54 offen lds
    s_addk_i32 m0, 1024
    s_addk_i32 s54, 4096
    buffer_load_dwordx4 v20, s[28:31], s54 offen lds
    s_addk_i32 m0, 1024
    s_addk_i32 s54, 4096
    buffer_load_dwordx4 v20, s[28:31], s54 offen lds
    s_addk_i32 m0, 1024
    s_addk_i32 s54, 4096
    buffer_load_dwordx4 v20, s[28:31], s54 offen lds
    s_waitcnt vmcnt(12)
    s_barrier
    s_add_u32 m0, s62, 131072
    s_mov_b32 s54, 0x2c000
    buffer_load_dwordx4 v20, s[28:31], s54 offen lds
    s_addk_i32 m0, 1024
    s_addk_i32 s54, 4096
    buffer_load_dwordx4 v20, s[28:31], s54 offen lds
    s_addk_i32 m0, 1024
    s_addk_i32 s54, 4096
    buffer_load_dwordx4 v20, s[28:31], s54 offen lds
    s_addk_i32 m0, 1024
    s_addk_i32 s54, 4096
    buffer_load_dwordx4 v20, s[28:31], s54 offen lds
    s_waitcnt vmcnt(12)
    s_barrier
    s_addk_i32 m0, 13312
    s_mov_b32 s54, 0x3c000
    buffer_load_dwordx4 v20, s[28:31], s54 offen lds
    s_addk_i32 m0, 1024
    s_addk_i32 s54, 4096
    buffer_load_dwordx4 v20, s[28:31], s54 offen lds
    s_addk_i32 m0, 1024
    s_addk_i32 s54, 4096
    buffer_load_dwordx4 v20, s[28:31], s54 offen lds
    s_addk_i32 m0, 1024
    s_addk_i32 s54, 4096
    buffer_load_dwordx4 v20, s[28:31], s54 offen lds
    s_waitcnt vmcnt(12)
    s_barrier
    s_add_u32 m0, s62, 65536
    s_nop 0
    buffer_load_dwordx4 v24, s[36:39], 0 offen lds
    s_addk_i32 m0, 1024
    s_mov_b32 s54, 0x1c00
    buffer_load_dwordx4 v24, s[36:39], s54 offen lds
    s_addk_i32 m0, 1024
    s_addk_i32 s54, 7168
    buffer_load_dwordx4 v24, s[36:39], s54 offen lds
    s_addk_i32 m0, 1024
    s_addk_i32 s54, 7168
    buffer_load_dwordx4 v24, s[36:39], s54 offen lds
    s_waitcnt vmcnt(12)
    s_barrier
    s_addk_i32 m0, 13312
    s_mov_b32 s54, 0x1c000
    buffer_load_dwordx4 v24, s[36:39], s54 offen lds
    s_addk_i32 m0, 1024
    s_addk_i32 s54, 7168
    buffer_load_dwordx4 v24, s[36:39], s54 offen lds
    s_addk_i32 m0, 1024
    s_addk_i32 s54, 7168
    buffer_load_dwordx4 v24, s[36:39], s54 offen lds
    s_addk_i32 m0, 1024
    s_addk_i32 s54, 7168
    buffer_load_dwordx4 v24, s[36:39], s54 offen lds
    s_waitcnt vmcnt(12)
    s_barrier
    s_addk_i32 m0, 13312
    s_mov_b32 s54, 0x80
    buffer_load_dwordx4 v24, s[36:39], s54 offen lds
    s_addk_i32 m0, 1024
    s_addk_i32 s54, 7168
    buffer_load_dwordx4 v24, s[36:39], s54 offen lds
    s_addk_i32 m0, 1024
    s_addk_i32 s54, 7168
    buffer_load_dwordx4 v24, s[36:39], s54 offen lds
    s_addk_i32 m0, 1024
    s_addk_i32 s54, 7168
    buffer_load_dwordx4 v24, s[36:39], s54 offen lds
    s_waitcnt vmcnt(12)
    s_barrier
    s_waitcnt vmcnt(8)
    s_barrier
    s_barrier
    s_addk_i32 m0, 13312
    s_mov_b32 s54, 0x1c080
    buffer_load_dwordx4 v24, s[36:39], s54 offen lds
    s_addk_i32 m0, 1024
    s_addk_i32 s54, 7168
    buffer_load_dwordx4 v24, s[36:39], s54 offen lds
    s_addk_i32 m0, 1024
    s_addk_i32 s54, 7168
    buffer_load_dwordx4 v24, s[36:39], s54 offen lds
    s_addk_i32 m0, 1024
    s_addk_i32 s54, 7168
    buffer_load_dwordx4 v24, s[36:39], s54 offen lds
    s_add_u32 m0, s62, 32768
    s_mov_b32 s54, 0x100
    buffer_load_dwordx4 v24, s[36:39], s54 offen lds
    s_waitcnt vmcnt(9)
    s_barrier
    s_addk_i32 m0, 1024
    s_addk_i32 s54, 7168
    buffer_load_dwordx4 v24, s[36:39], s54 offen lds
    s_addk_i32 m0, 1024
    s_addk_i32 s54, 7168
    buffer_load_dwordx4 v24, s[36:39], s54 offen lds
    s_addk_i32 m0, 1024
    s_addk_i32 s54, 7168
    buffer_load_dwordx4 v24, s[36:39], s54 offen lds
    s_addk_i32 m0, 13312
    s_mov_b32 s54, 0x1c100
    buffer_load_dwordx4 v24, s[36:39], s54 offen lds
    s_addk_i32 m0, 1024
    s_addk_i32 s54, 7168
    buffer_load_dwordx4 v24, s[36:39], s54 offen lds
    s_waitcnt vmcnt(10)
    s_barrier
    s_addk_i32 m0, 1024
    s_addk_i32 s54, 7168
    buffer_load_dwordx4 v24, s[36:39], s54 offen lds
    s_addk_i32 m0, 1024
    s_addk_i32 s54, 7168
    buffer_load_dwordx4 v24, s[36:39], s54 offen lds
    s_add_u32 m0, s62, 131072
    s_mov_b32 s54, 0x180
    buffer_load_dwordx4 v24, s[36:39], s54 offen lds
    s_addk_i32 m0, 1024
    s_addk_i32 s54, 7168
    buffer_load_dwordx4 v24, s[36:39], s54 offen lds
    s_addk_i32 m0, 1024
    s_addk_i32 s54, 7168
    buffer_load_dwordx4 v24, s[36:39], s54 offen lds
    s_waitcnt vmcnt(11)
    s_barrier
    s_addk_i32 m0, 1024
    s_addk_i32 s54, 7168
    buffer_load_dwordx4 v24, s[36:39], s54 offen lds
    s_addk_i32 m0, 13312
    s_mov_b32 s54, 0x1c180
    buffer_load_dwordx4 v24, s[36:39], s54 offen lds
    s_addk_i32 m0, 1024
    s_addk_i32 s54, 7168
    buffer_load_dwordx4 v24, s[36:39], s54 offen lds
    s_addk_i32 m0, 1024
    s_addk_i32 s54, 7168
    buffer_load_dwordx4 v24, s[36:39], s54 offen lds
    s_addk_i32 m0, 1024
    s_addk_i32 s54, 7168
    buffer_load_dwordx4 v24, s[36:39], s54 offen lds
    s_waitcnt vmcnt(12)
    s_barrier
    s_add_u32 m0, s62, 65536
    s_mov_b32 s54, 0x200
    buffer_load_dwordx4 v24, s[36:39], s54 offen lds
    s_addk_i32 m0, 1024
    s_addk_i32 s54, 7168
    buffer_load_dwordx4 v24, s[36:39], s54 offen lds
    s_addk_i32 m0, 1024
    s_addk_i32 s54, 7168
    buffer_load_dwordx4 v24, s[36:39], s54 offen lds
    s_addk_i32 m0, 1024
    s_addk_i32 s54, 7168
    buffer_load_dwordx4 v24, s[36:39], s54 offen lds
    s_waitcnt vmcnt(12)
    s_barrier
    s_addk_i32 m0, 13312
    s_mov_b32 s54, 0x1c200
    buffer_load_dwordx4 v24, s[36:39], s54 offen lds
    s_addk_i32 m0, 1024
    s_addk_i32 s54, 7168
    buffer_load_dwordx4 v24, s[36:39], s54 offen lds
    s_addk_i32 m0, 1024
    s_addk_i32 s54, 7168
    buffer_load_dwordx4 v24, s[36:39], s54 offen lds
    s_addk_i32 m0, 1024
    s_addk_i32 s54, 7168
    buffer_load_dwordx4 v24, s[36:39], s54 offen lds
    s_waitcnt vmcnt(12)
    s_barrier
    s_addk_i32 m0, 13312
    s_mov_b32 s54, 0x280
    buffer_load_dwordx4 v24, s[36:39], s54 offen lds
    s_addk_i32 m0, 1024
    s_addk_i32 s54, 7168
    buffer_load_dwordx4 v24, s[36:39], s54 offen lds
    s_addk_i32 m0, 1024
    s_addk_i32 s54, 7168
    buffer_load_dwordx4 v24, s[36:39], s54 offen lds
    s_addk_i32 m0, 1024
    s_addk_i32 s54, 7168
    buffer_load_dwordx4 v24, s[36:39], s54 offen lds
    s_waitcnt vmcnt(12)
    s_barrier
    s_addk_i32 m0, 13312
    s_mov_b32 s54, 0x1c280
    buffer_load_dwordx4 v24, s[36:39], s54 offen lds
    s_addk_i32 m0, 1024
    s_addk_i32 s54, 7168
    buffer_load_dwordx4 v24, s[36:39], s54 offen lds
    s_addk_i32 m0, 1024
    s_addk_i32 s54, 7168
    buffer_load_dwordx4 v24, s[36:39], s54 offen lds
    s_addk_i32 m0, 1024
    s_addk_i32 s54, 7168
    buffer_load_dwordx4 v24, s[36:39], s54 offen lds
    s_waitcnt vmcnt(12)
    s_barrier
    s_add_u32 m0, s62, 32768
    s_mov_b32 s54, 0x300
    buffer_load_dwordx4 v24, s[36:39], s54 offen lds
    s_addk_i32 m0, 1024
    s_addk_i32 s54, 7168
    buffer_load_dwordx4 v24, s[36:39], s54 offen lds
    s_addk_i32 m0, 1024
    s_addk_i32 s54, 7168
    buffer_load_dwordx4 v24, s[36:39], s54 offen lds
    s_addk_i32 m0, 1024
    s_addk_i32 s54, 7168
    buffer_load_dwordx4 v24, s[36:39], s54 offen lds
    s_waitcnt vmcnt(12)
    s_barrier
    s_addk_i32 m0, 13312
    s_mov_b32 s54, 0x1c300
    buffer_load_dwordx4 v24, s[36:39], s54 offen lds
    s_addk_i32 m0, 1024
    s_addk_i32 s54, 7168
    buffer_load_dwordx4 v24, s[36:39], s54 offen lds
    s_addk_i32 m0, 1024
    s_addk_i32 s54, 7168
    buffer_load_dwordx4 v24, s[36:39], s54 offen lds
    s_addk_i32 m0, 1024
    s_addk_i32 s54, 7168
    buffer_load_dwordx4 v24, s[36:39], s54 offen lds
    s_waitcnt vmcnt(12)
    s_barrier
    s_waitcnt vmcnt(8)
    s_barrier
    s_waitcnt vmcnt(4)
    s_barrier
    s_waitcnt vmcnt(0)
    s_barrier
    s_endpgm
K1_COMPUTE:
    s_mov_b32 s48, 0x3db8aa3b
    s_lshl_b32 s50, s56, 4
    s_add_u32 s50, s50, s44
    s_mul_i32 s50, s50, 57344
    s_waitcnt lgkmcnt(0)
    s_add_u32 s40, s18, s50
    s_addc_u32 s41, s19, 0
    s_mov_b32 s42, 0xe000
    s_mov_b32 s43, 0x00020000
    v_lshlrev_b32 v2, 4, v0
    v_bfe_u32 v3, v0, 2, 2
    v_lshlrev_b32 v3, 7, v3
    v_lshrrev_b32 v1, 4, v0
    v_lshl_add_u32 v3, v1, 10, v3
    v_and_b32 v1, 3, v0
    v_lshl_add_u32 v3, v1, 3, v3
    v_bfe_u32 v1, v0, 3, 2
    v_lshl_add_u32 v4, v1, 5, v3
    s_lshl_b32 s50, s3, 12
    v_add_u32 v4, s50, v4
    v_and_b32 v3, 15, v0
    v_bfe_u32 v1, v0, 1, 3
    v_lshrrev_b32 v14, 4, v0
    v_xor_b32 v1, v1, v14
    v_lshlrev_b32 v1, 4, v1
    v_lshl_add_u32 v5, v3, 7, v1
    v_xor_b32 v6, 64, v5
    s_barrier
    v_add_u32 v8, 0x8000, v4
    v_xor_b32 v9, 32, v8
    v_xor_b32 v10, 64, v8
    v_xor_b32 v11, 96, v8
    ds_read_b64_tr_b16 v[16:17], v8 offset:0
    ds_read_b64_tr_b16 v[18:19], v8 offset:512
    ds_read_b128 v[32:35], v5 offset:0
    ds_read_b128 v[36:39], v5 offset:2048
    ds_read_b64_tr_b16 v[20:21], v9 offset:0
    ds_read_b64_tr_b16 v[22:23], v9 offset:512
    ds_read_b64_tr_b16 v[24:25], v10 offset:0
    ds_read_b64_tr_b16 v[26:27], v10 offset:512
    ds_read_b64_tr_b16 v[28:29], v11 offset:0
    ds_read_b64_tr_b16 v[30:31], v11 offset:512
    ds_read_b128 v[40:43], v5 offset:4096
    ds_read_b128 v[44:47], v5 offset:6144
    s_waitcnt lgkmcnt(9)
    v_mfma_f32_16x16x32_bf16 v[64:67], v[16:19], v[32:35], 0
    s_waitcnt lgkmcnt(8)
    v_mfma_f32_16x16x32_bf16 v[68:71], v[16:19], v[36:39], 0
    s_waitcnt lgkmcnt(6)
    v_mfma_f32_16x16x32_bf16 v[80:83], v[20:23], v[32:35], 0
    v_mfma_f32_16x16x32_bf16 v[84:87], v[20:23], v[36:39], 0
    s_waitcnt lgkmcnt(4)
    v_mfma_f32_16x16x32_bf16 v[96:99], v[24:27], v[32:35], 0
    v_mfma_f32_16x16x32_bf16 v[100:103], v[24:27], v[36:39], 0
    s_barrier
    s_waitcnt lgkmcnt(2)
    v_mfma_f32_16x16x32_bf16 v[112:115], v[28:31], v[32:35], 0
    ds_read_b128 v[32:35], v6 offset:0
    v_mfma_f32_16x16x32_bf16 v[116:119], v[28:31], v[36:39], 0
    ds_read_b128 v[36:39], v6 offset:2048
    s_waitcnt lgkmcnt(3)
    v_mfma_f32_16x16x32_bf16 v[72:75], v[16:19], v[40:43], 0
    s_waitcnt lgkmcnt(2)
    v_mfma_f32_16x16x32_bf16 v[76:79], v[16:19], v[44:47], 0
    v_add_u32 v8, 0xc000, v4
    v_xor_b32 v9, 32, v8
    v_xor_b32 v10, 64, v8
    v_xor_b32 v11, 96, v8
    ds_read_b64_tr_b16 v[16:17], v8 offset:0
    ds_read_b64_tr_b16 v[18:19], v8 offset:512
    v_mfma_f32_16x16x32_bf16 v[88:91], v[20:23], v[40:43], 0
    v_mfma_f32_16x16x32_bf16 v[92:95], v[20:23], v[44:47], 0
    ds_read_b64_tr_b16 v[20:21], v9 offset:0
    ds_read_b64_tr_b16 v[22:23], v9 offset:512
    v_mfma_f32_16x16x32_bf16 v[104:107], v[24:27], v[40:43], 0
    v_mfma_f32_16x16x32_bf16 v[108:111], v[24:27], v[44:47], 0
    ds_read_b64_tr_b16 v[24:25], v10 offset:0
    ds_read_b64_tr_b16 v[26:27], v10 offset:512
    v_mfma_f32_16x16x32_bf16 v[120:123], v[28:31], v[40:43], 0
    ds_read_b128 v[40:43], v6 offset:4096
    v_mfma_f32_16x16x32_bf16 v[124:127], v[28:31], v[44:47], 0
    ds_read_b64_tr_b16 v[28:29], v11 offset:0
    ds_read_b64_tr_b16 v[30:31], v11 offset:512
    s_waitcnt lgkmcnt(7)
    v_mfma_f32_16x16x32_bf16 v[64:67], v[16:19], v[32:35], v[64:67]
    ds_read_b128 v[44:47], v6 offset:6144
    v_mfma_f32_16x16x32_bf16 v[68:71], v[16:19], v[36:39], v[68:71]
    s_waitcnt lgkmcnt(6)
    v_mfma_f32_16x16x32_bf16 v[80:83], v[20:23], v[32:35], v[80:83]
    v_mfma_f32_16x16x32_bf16 v[84:87], v[20:23], v[36:39], v[84:87]
    s_waitcnt lgkmcnt(4)
    v_mfma_f32_16x16x32_bf16 v[96:99], v[24:27], v[32:35], v[96:99]
    s_waitcnt vmcnt(0)
    v_mfma_f32_16x16x32_bf16 v[100:103], v[24:27], v[36:39], v[100:103]
    s_barrier
    s_waitcnt lgkmcnt(1)
    v_mfma_f32_16x16x32_bf16 v[112:115], v[28:31], v[32:35], v[112:115]
    ds_read_b128 v[32:35], v5 offset:8192
    v_mfma_f32_16x16x32_bf16 v[116:119], v[28:31], v[36:39], v[116:119]
    ds_read_b128 v[36:39], v5 offset:10240
    v_add_u32 v62, 0x20000, v5
    v_mfma_f32_16x16x32_bf16 v[72:75], v[16:19], v[40:43], v[72:75]
    s_waitcnt lgkmcnt(2)
    v_mfma_f32_16x16x32_bf16 v[76:79], v[16:19], v[44:47], v[76:79]
    v_add_u32 v8, 0x10000, v4
    v_xor_b32 v9, 32, v8
    v_xor_b32 v10, 64, v8
    v_xor_b32 v11, 96, v8
    ds_read_b64_tr_b16 v[16:17], v8 offset:0
    ds_read_b64_tr_b16 v[18:19], v8 offset:512
    v_mfma_f32_16x16x32_bf16 v[88:91], v[20:23], v[40:43], v[88:91]
    v_mfma_f32_16x16x32_bf16 v[92:95], v[20:23], v[44:47], v[92:95]
    ds_read_b64_tr_b16 v[20:21], v9 offset:0
    ds_read_b64_tr_b16 v[22:23], v9 offset:512
    v_mfma_f32_16x16x32_bf16 v[104:107], v[24:27], v[40:43], v[104:107]
    v_add_u32 v63, 0x20000, v6
    v_mfma_f32_16x16x32_bf16 v[108:111], v[24:27], v[44:47], v[108:111]
    ds_read_b64_tr_b16 v[24:25], v10 offset:0
    ds_read_b64_tr_b16 v[26:27], v10 offset:512
    v_mfma_f32_16x16x32_bf16 v[120:123], v[28:31], v[40:43], v[120:123]
    ds_read_b128 v[40:43], v5 offset:12288
    v_and_b32 v59, 15, v0
    v_mfma_f32_16x16x32_bf16 v[124:127], v[28:31], v[44:47], v[124:127]
    ds_read_b64_tr_b16 v[28:29], v11 offset:0
    ds_read_b64_tr_b16 v[30:31], v11 offset:512
    s_waitcnt lgkmcnt(7)
    v_mfma_f32_16x16x32_bf16 v[64:67], v[16:19], v[32:35], v[64:67]
    ds_read_b128 v[44:47], v5 offset:14336
    v_mfma_f32_16x16x32_bf16 v[68:71], v[16:19], v[36:39], v[68:71]
    s_waitcnt lgkmcnt(6)
    v_mfma_f32_16x16x32_bf16 v[80:83], v[20:23], v[32:35], v[80:83]
    v_lshlrev_b32 v59, 4, v59
    v_mfma_f32_16x16x32_bf16 v[84:87], v[20:23], v[36:39], v[84:87]
    s_waitcnt lgkmcnt(4)
    v_mfma_f32_16x16x32_bf16 v[96:99], v[24:27], v[32:35], v[96:99]
    v_mfma_f32_16x16x32_bf16 v[100:103], v[24:27], v[36:39], v[100:103]
    s_barrier
    v_add_u32 v59, 0x24000, v59
    s_waitcnt lgkmcnt(1)
    v_mfma_f32_16x16x32_bf16 v[112:115], v[28:31], v[32:35], v[112:115]
    ds_read_b128 v[32:35], v6 offset:8192
    v_mfma_f32_16x16x32_bf16 v[116:119], v[28:31], v[36:39], v[116:119]
    ds_read_b128 v[36:39], v6 offset:10240
    v_mfma_f32_16x16x32_bf16 v[72:75], v[16:19], v[40:43], v[72:75]
    s_lshl_b32 s50, s3, 2
    s_waitcnt lgkmcnt(2)
    v_mfma_f32_16x16x32_bf16 v[76:79], v[16:19], v[44:47], v[76:79]
    v_add_u32 v8, 0x14000, v4
    v_xor_b32 v9, 32, v8
    v_xor_b32 v10, 64, v8
    v_xor_b32 v11, 96, v8
    ds_read_b64_tr_b16 v[16:17], v8 offset:0
    ds_read_b64_tr_b16 v[18:19], v8 offset:512
    v_mfma_f32_16x16x32_bf16 v[88:91], v[20:23], v[40:43], v[88:91]
    v_mfma_f32_16x16x32_bf16 v[92:95], v[20:23], v[44:47], v[92:95]
    ds_read_b64_tr_b16 v[20:21], v9 offset:0
    ds_read_b64_tr_b16 v[22:23], v9 offset:512
    v_mfma_f32_16x16x32_bf16 v[104:107], v[24:27], v[40:43], v[104:107]
    v_add_u32 v58, s50, v59
    v_mfma_f32_16x16x32_bf16 v[108:111], v[24:27], v[44:47], v[108:111]
    ds_read_b64_tr_b16 v[24:25], v10 offset:0
    ds_read_b64_tr_b16 v[26:27], v10 offset:512
    v_mfma_f32_16x16x32_bf16 v[120:123], v[28:31], v[40:43], v[120:123]
    ds_read_b128 v[40:43], v6 offset:12288
    s_lshl_b32 s50, s3, 12
    v_mfma_f32_16x16x32_bf16 v[124:127], v[28:31], v[44:47], v[124:127]
    ds_read_b64_tr_b16 v[28:29], v11 offset:0
    ds_read_b64_tr_b16 v[30:31], v11 offset:512
    s_waitcnt lgkmcnt(7)
    v_mfma_f32_16x16x32_bf16 v[64:67], v[16:19], v[32:35], v[64:67]
    ds_read_b128 v[44:47], v6 offset:14336
    v_add_u32 v60, s50, v2
    v_mfma_f32_16x16x32_bf16 v[68:71], v[16:19], v[36:39], v[68:71]
    s_waitcnt lgkmcnt(6)
    v_mfma_f32_16x16x32_bf16 v[80:83], v[20:23], v[32:35], v[80:83]
    v_mfma_f32_16x16x32_bf16 v[84:87], v[20:23], v[36:39], v[84:87]
    s_lshl_b32 s50, s3, 13
    s_waitcnt lgkmcnt(4)
    v_mfma_f32_16x16x32_bf16 v[96:99], v[24:27], v[32:35], v[96:99]
    v_mfma_f32_16x16x32_bf16 v[100:103], v[24:27], v[36:39], v[100:103]
    s_barrier
    v_add_u32 v7, s50, v2
    s_waitcnt lgkmcnt(1)
    v_mfma_f32_16x16x32_bf16 v[112:115], v[28:31], v[32:35], v[112:115]
    ds_read_b128 v[32:35], v5 offset:16384
    v_mfma_f32_16x16x32_bf16 v[116:119], v[28:31], v[36:39], v[116:119]
    ds_read_b128 v[36:39], v5 offset:18432
    v_mfma_f32_16x16x32_bf16 v[72:75], v[16:19], v[40:43], v[72:75]
    s_waitcnt lgkmcnt(2)
    v_mfma_f32_16x16x32_bf16 v[76:79], v[16:19], v[44:47], v[76:79]
    v_add_u32 v8, 0x18000, v4
    v_xor_b32 v9, 32, v8
    v_xor_b32 v10, 64, v8
    v_xor_b32 v11, 96, v8
    ds_read_b64_tr_b16 v[16:17], v8 offset:0
    ds_read_b64_tr_b16 v[18:19], v8 offset:512
    v_mfma_f32_16x16x32_bf16 v[88:91], v[20:23], v[40:43], v[88:91]
    v_and_b32 v3, 15, v0
    v_mfma_f32_16x16x32_bf16 v[92:95], v[20:23], v[44:47], v[92:95]
    ds_read_b64_tr_b16 v[20:21], v9 offset:0
    ds_read_b64_tr_b16 v[22:23], v9 offset:512
    v_mfma_f32_16x16x32_bf16 v[104:107], v[24:27], v[40:43], v[104:107]
    v_lshlrev_b32 v3, 4, v3
    v_mfma_f32_16x16x32_bf16 v[108:111], v[24:27], v[44:47], v[108:111]
    ds_read_b64_tr_b16 v[24:25], v10 offset:0
    ds_read_b64_tr_b16 v[26:27], v10 offset:512
    v_mfma_f32_16x16x32_bf16 v[120:123], v[28:31], v[40:43], v[120:123]
    ds_read_b128 v[40:43], v5 offset:20480
    v_mfma_f32_16x16x32_bf16 v[124:127], v[28:31], v[44:47], v[124:127]
    ds_read_b64_tr_b16 v[28:29], v11 offset:0
    ds_read_b64_tr_b16 v[30:31], v11 offset:512
    s_waitcnt lgkmcnt(7)
    v_mfma_f32_16x16x32_bf16 v[64:67], v[16:19], v[32:35], v[64:67]
    ds_read_b128 v[44:47], v5 offset:22528
    v_bfe_u32 v1, v0, 5, 1
    v_mfma_f32_16x16x32_bf16 v[68:71], v[16:19], v[36:39], v[68:71]
    s_waitcnt lgkmcnt(6)
    v_mfma_f32_16x16x32_bf16 v[80:83], v[20:23], v[32:35], v[80:83]
    v_mfma_f32_16x16x32_bf16 v[84:87], v[20:23], v[36:39], v[84:87]
    s_waitcnt lgkmcnt(4)
    v_mfma_f32_16x16x32_bf16 v[96:99], v[24:27], v[32:35], v[96:99]
    v_lshl_add_u32 v3, v1, 8, v3
    v_mfma_f32_16x16x32_bf16 v[100:103], v[24:27], v[36:39], v[100:103]
    s_barrier
    s_waitcnt lgkmcnt(1)
    v_mfma_f32_16x16x32_bf16 v[112:115], v[28:31], v[32:35], v[112:115]
    ds_read_b128 v[32:35], v6 offset:16384
    v_mfma_f32_16x16x32_bf16 v[116:119], v[28:31], v[36:39], v[116:119]
    ds_read_b128 v[36:39], v6 offset:18432
    v_bfe_u32 v1, v0, 4, 1
    v_mfma_f32_16x16x32_bf16 v[72:75], v[16:19], v[40:43], v[72:75]
    s_waitcnt lgkmcnt(2)
    v_mfma_f32_16x16x32_bf16 v[76:79], v[16:19], v[44:47], v[76:79]
    v_add_u32 v8, 0x1c000, v4
    v_xor_b32 v9, 32, v8
    v_xor_b32 v10, 64, v8
    v_xor_b32 v11, 96, v8
    ds_read_b64_tr_b16 v[16:17], v8 offset:0
    ds_read_b64_tr_b16 v[18:19], v8 offset:512
    v_mfma_f32_16x16x32_bf16 v[88:91], v[20:23], v[40:43], v[88:91]
    v_mfma_f32_16x16x32_bf16 v[92:95], v[20:23], v[44:47], v[92:95]
    ds_read_b64_tr_b16 v[20:21], v9 offset:0
    ds_read_b64_tr_b16 v[22:23], v9 offset:512
    v_mfma_f32_16x16x32_bf16 v[104:107], v[24:27], v[40:43], v[104:107]
    v_lshl_add_u32 v3, v1, 3, v3
    v_mfma_f32_16x16x32_bf16 v[108:111], v[24:27], v[44:47], v[108:111]
    ds_read_b64_tr_b16 v[24:25], v10 offset:0
    ds_read_b64_tr_b16 v[26:27], v10 offset:512
    v_mfma_f32_16x16x32_bf16 v[120:123], v[28:31], v[40:43], v[120:123]
    ds_read_b128 v[40:43], v6 offset:20480
    v_add_u32 v61, s50, v3
    v_mfma_f32_16x16x32_bf16 v[124:127], v[28:31], v[44:47], v[124:127]
    ds_read_b64_tr_b16 v[28:29], v11 offset:0
    ds_read_b64_tr_b16 v[30:31], v11 offset:512
    s_waitcnt lgkmcnt(7)
    v_mfma_f32_16x16x32_bf16 v[64:67], v[16:19], v[32:35], v[64:67]
    ds_read_b128 v[44:47], v6 offset:22528
    v_mfma_f32_16x16x32_bf16 v[68:71], v[16:19], v[36:39], v[68:71]
    s_waitcnt lgkmcnt(6)
    v_mfma_f32_16x16x32_bf16 v[80:83], v[20:23], v[32:35], v[80:83]
    v_and_b32 v3, 15, v0
    v_mfma_f32_16x16x32_bf16 v[84:87], v[20:23], v[36:39], v[84:87]
    s_waitcnt lgkmcnt(4)
    v_mfma_f32_16x16x32_bf16 v[96:99], v[24:27], v[32:35], v[96:99]
    v_mfma_f32_16x16x32_bf16 v[100:103], v[24:27], v[36:39], v[100:103]
    s_barrier
    v_bfe_u32 v1, v0, 1, 3
    s_waitcnt lgkmcnt(1)
    v_mfma_f32_16x16x32_bf16 v[112:115], v[28:31], v[32:35], v[112:115]
    ds_read_b128 v[32:35], v5 offset:24576
    v_mfma_f32_16x16x32_bf16 v[116:119], v[28:31], v[36:39], v[116:119]
    ds_read_b128 v[36:39], v5 offset:26624
    v_mfma_f32_16x16x32_bf16 v[72:75], v[16:19], v[40:43], v[72:75]
    s_waitcnt lgkmcnt(2)
    v_mfma_f32_16x16x32_bf16 v[76:79], v[16:19], v[44:47], v[76:79]
    v_add_u32 v8, 0x8000, v4
    v_xor_b32 v9, 32, v8
    v_xor_b32 v10, 64, v8
    v_xor_b32 v11, 96, v8
    ds_read_b64_tr_b16 v[16:17], v8 offset:0
    ds_read_b64_tr_b16 v[18:19], v8 offset:512
    v_mfma_f32_16x16x32_bf16 v[88:91], v[20:23], v[40:43], v[88:91]
    v_lshrrev_b32 v14, 4, v0
    v_mfma_f32_16x16x32_bf16 v[92:95], v[20:23], v[44:47], v[92:95]
    ds_read_b64_tr_b16 v[20:21], v9 offset:0
    ds_read_b64_tr_b16 v[22:23], v9 offset:512
    v_mfma_f32_16x16x32_bf16 v[104:107], v[24:27], v[40:43], v[104:107]
    v_xor_b32 v1, v1, v14
    v_mfma_f32_16x16x32_bf16 v[108:111], v[24:27], v[44:47], v[108:111]
    ds_read_b64_tr_b16 v[24:25], v10 offset:0
    ds_read_b64_tr_b16 v[26:27], v10 offset:512
    v_mfma_f32_16x16x32_bf16 v[120:123], v[28:31], v[40:43], v[120:123]
    ds_read_b128 v[40:43], v5 offset:28672
    v_mfma_f32_16x16x32_bf16 v[124:127], v[28:31], v[44:47], v[124:127]
    ds_read_b64_tr_b16 v[28:29], v11 offset:0
    ds_read_b64_tr_b16 v[30:31], v11 offset:512
    s_waitcnt lgkmcnt(7)
    v_mfma_f32_16x16x32_bf16 v[64:67], v[16:19], v[32:35], v[64:67]
    ds_read_b128 v[44:47], v5 offset:30720
    v_lshlrev_b32 v1, 4, v1
    v_mfma_f32_16x16x32_bf16 v[68:71], v[16:19], v[36:39], v[68:71]
    s_waitcnt lgkmcnt(6)
    v_mfma_f32_16x16x32_bf16 v[80:83], v[20:23], v[32:35], v[80:83]
    v_mfma_f32_16x16x32_bf16 v[84:87], v[20:23], v[36:39], v[84:87]
    s_waitcnt lgkmcnt(4)
    v_mfma_f32_16x16x32_bf16 v[96:99], v[24:27], v[32:35], v[96:99]
    v_lshl_add_u32 v56, v3, 7, v1
    v_mfma_f32_16x16x32_bf16 v[100:103], v[24:27], v[36:39], v[100:103]
    s_barrier
    s_waitcnt lgkmcnt(1)
    v_mfma_f32_16x16x32_bf16 v[112:115], v[28:31], v[32:35], v[112:115]
    ds_read_b128 v[32:35], v6 offset:24576
    s_lshl_b32 s50, s3, 12
    v_mfma_f32_16x16x32_bf16 v[116:119], v[28:31], v[36:39], v[116:119]
    ds_read_b128 v[36:39], v6 offset:26624
    v_mfma_f32_16x16x32_bf16 v[72:75], v[16:19], v[40:43], v[72:75]
    s_waitcnt lgkmcnt(2)
    v_mfma_f32_16x16x32_bf16 v[76:79], v[16:19], v[44:47], v[76:79]
    v_add_u32 v8, 0xc000, v4
    v_xor_b32 v9, 32, v8
    v_xor_b32 v10, 64, v8
    v_xor_b32 v11, 96, v8
    ds_read_b64_tr_b16 v[16:17], v8 offset:0
    ds_read_b64_tr_b16 v[18:19], v8 offset:512
    v_mfma_f32_16x16x32_bf16 v[88:91], v[20:23], v[40:43], v[88:91]
    v_add_u32 v56, s50, v56
    v_mfma_f32_16x16x32_bf16 v[92:95], v[20:23], v[44:47], v[92:95]
    ds_read_b64_tr_b16 v[20:21], v9 offset:0
    ds_read_b64_tr_b16 v[22:23], v9 offset:512
    v_mfma_f32_16x16x32_bf16 v[104:107], v[24:27], v[40:43], v[104:107]
    v_xor_b32 v57, 64, v56
    v_mfma_f32_16x16x32_bf16 v[108:111], v[24:27], v[44:47], v[108:111]
    ds_read_b64_tr_b16 v[24:25], v10 offset:0
    ds_read_b64_tr_b16 v[26:27], v10 offset:512
    v_mfma_f32_16x16x32_bf16 v[120:123], v[28:31], v[40:43], v[120:123]
    ds_read_b128 v[40:43], v6 offset:28672
    v_mfma_f32_16x16x32_bf16 v[124:127], v[28:31], v[44:47], v[124:127]
    ds_read_b64_tr_b16 v[28:29], v11 offset:0
    ds_read_b64_tr_b16 v[30:31], v11 offset:512
    s_waitcnt lgkmcnt(7)
    v_mfma_f32_16x16x32_bf16 v[64:67], v[16:19], v[32:35], v[64:67]
    ds_read_b128 v[44:47], v6 offset:30720
    v_mfma_f32_16x16x32_bf16 v[68:71], v[16:19], v[36:39], v[68:71]
    s_waitcnt lgkmcnt(6)
    v_mfma_f32_16x16x32_bf16 v[80:83], v[20:23], v[32:35], v[80:83]
    v_mfma_f32_16x16x32_bf16 v[84:87], v[20:23], v[36:39], v[84:87]
    s_waitcnt lgkmcnt(4)
    v_mfma_f32_16x16x32_bf16 v[96:99], v[24:27], v[32:35], v[96:99]
    v_mfma_f32_16x16x32_bf16 v[100:103], v[24:27], v[36:39], v[100:103]
    s_barrier
    s_waitcnt lgkmcnt(1)
    v_mfma_f32_16x16x32_bf16 v[112:115], v[28:31], v[32:35], v[112:115]
    ds_read_b128 v[32:35], v62 offset:0
    v_mfma_f32_16x16x32_bf16 v[116:119], v[28:31], v[36:39], v[116:119]
    ds_read_b128 v[36:39], v62 offset:2048
    v_mfma_f32_16x16x32_bf16 v[72:75], v[16:19], v[40:43], v[72:75]
    s_waitcnt lgkmcnt(2)
    v_mfma_f32_16x16x32_bf16 v[76:79], v[16:19], v[44:47], v[76:79]
    v_add_u32 v8, 0x10000, v4
    v_xor_b32 v9, 32, v8
    v_xor_b32 v10, 64, v8
    v_xor_b32 v11, 96, v8
    ds_read_b64_tr_b16 v[16:17], v8 offset:0
    ds_read_b64_tr_b16 v[18:19], v8 offset:512
    v_mfma_f32_16x16x32_bf16 v[88:91], v[20:23], v[40:43], v[88:91]
    v_mfma_f32_16x16x32_bf16 v[92:95], v[20:23], v[44:47], v[92:95]
    ds_read_b64_tr_b16 v[20:21], v9 offset:0
    ds_read_b64_tr_b16 v[22:23], v9 offset:512
    v_mfma_f32_16x16x32_bf16 v[104:107], v[24:27], v[40:43], v[104:107]
    v_mfma_f32_16x16x32_bf16 v[108:111], v[24:27], v[44:47], v[108:111]
    ds_read_b64_tr_b16 v[24:25], v10 offset:0
    ds_read_b64_tr_b16 v[26:27], v10 offset:512
    v_mfma_f32_16x16x32_bf16 v[120:123], v[28:31], v[40:43], v[120:123]
    ds_read_b128 v[40:43], v62 offset:4096
    v_mfma_f32_16x16x32_bf16 v[124:127], v[28:31], v[44:47], v[124:127]
    ds_read_b64_tr_b16 v[28:29], v11 offset:0
    ds_read_b64_tr_b16 v[30:31], v11 offset:512
    s_waitcnt lgkmcnt(7)
    v_mfma_f32_16x16x32_bf16 v[64:67], v[16:19], v[32:35], v[64:67]
    ds_read_b128 v[44:47], v62 offset:6144
    v_mfma_f32_16x16x32_bf16 v[68:71], v[16:19], v[36:39], v[68:71]
    s_waitcnt lgkmcnt(6)
    v_mfma_f32_16x16x32_bf16 v[80:83], v[20:23], v[32:35], v[80:83]
    v_mfma_f32_16x16x32_bf16 v[84:87], v[20:23], v[36:39], v[84:87]
    s_waitcnt lgkmcnt(4)
    v_mfma_f32_16x16x32_bf16 v[96:99], v[24:27], v[32:35], v[96:99]
    v_mfma_f32_16x16x32_bf16 v[100:103], v[24:27], v[36:39], v[100:103]
    s_barrier
    s_waitcnt lgkmcnt(1)
    v_mfma_f32_16x16x32_bf16 v[112:115], v[28:31], v[32:35], v[112:115]
    ds_read_b128 v[32:35], v63 offset:0
    v_mfma_f32_16x16x32_bf16 v[116:119], v[28:31], v[36:39], v[116:119]
    ds_read_b128 v[36:39], v63 offset:2048
    v_mfma_f32_16x16x32_bf16 v[72:75], v[16:19], v[40:43], v[72:75]
    s_waitcnt lgkmcnt(2)
    v_mfma_f32_16x16x32_bf16 v[76:79], v[16:19], v[44:47], v[76:79]
    v_add_u32 v8, 0x14000, v4
    v_xor_b32 v9, 32, v8
    v_xor_b32 v10, 64, v8
    v_xor_b32 v11, 96, v8
    ds_read_b64_tr_b16 v[16:17], v8 offset:0
    ds_read_b64_tr_b16 v[18:19], v8 offset:512
    v_mfma_f32_16x16x32_bf16 v[88:91], v[20:23], v[40:43], v[88:91]
    v_mfma_f32_16x16x32_bf16 v[92:95], v[20:23], v[44:47], v[92:95]
    ds_read_b64_tr_b16 v[20:21], v9 offset:0
    ds_read_b64_tr_b16 v[22:23], v9 offset:512
    v_mfma_f32_16x16x32_bf16 v[104:107], v[24:27], v[40:43], v[104:107]
    v_mfma_f32_16x16x32_bf16 v[108:111], v[24:27], v[44:47], v[108:111]
    ds_read_b64_tr_b16 v[24:25], v10 offset:0
    ds_read_b64_tr_b16 v[26:27], v10 offset:512
    v_mfma_f32_16x16x32_bf16 v[120:123], v[28:31], v[40:43], v[120:123]
    ds_read_b128 v[40:43], v63 offset:4096
    v_mfma_f32_16x16x32_bf16 v[124:127], v[28:31], v[44:47], v[124:127]
    ds_read_b64_tr_b16 v[28:29], v11 offset:0
    ds_read_b64_tr_b16 v[30:31], v11 offset:512
    s_waitcnt lgkmcnt(7)
    v_mfma_f32_16x16x32_bf16 v[64:67], v[16:19], v[32:35], v[64:67]
    ds_read_b128 v[44:47], v63 offset:6144
    v_mfma_f32_16x16x32_bf16 v[68:71], v[16:19], v[36:39], v[68:71]
    s_waitcnt lgkmcnt(6)
    v_mfma_f32_16x16x32_bf16 v[80:83], v[20:23], v[32:35], v[80:83]
    v_mfma_f32_16x16x32_bf16 v[84:87], v[20:23], v[36:39], v[84:87]
    s_waitcnt lgkmcnt(4)
    v_mfma_f32_16x16x32_bf16 v[96:99], v[24:27], v[32:35], v[96:99]
    v_mfma_f32_16x16x32_bf16 v[100:103], v[24:27], v[36:39], v[100:103]
    s_barrier
    s_waitcnt lgkmcnt(1)
    v_mfma_f32_16x16x32_bf16 v[112:115], v[28:31], v[32:35], v[112:115]
    ds_read_b128 v[32:35], v62 offset:8192
    v_mfma_f32_16x16x32_bf16 v[116:119], v[28:31], v[36:39], v[116:119]
    ds_read_b128 v[36:39], v62 offset:10240
    v_mfma_f32_16x16x32_bf16 v[72:75], v[16:19], v[40:43], v[72:75]
    s_waitcnt lgkmcnt(2)
    v_mfma_f32_16x16x32_bf16 v[76:79], v[16:19], v[44:47], v[76:79]
    v_add_u32 v8, 0x18000, v4
    v_xor_b32 v9, 32, v8
    v_xor_b32 v10, 64, v8
    v_xor_b32 v11, 96, v8
    ds_read_b64_tr_b16 v[16:17], v8 offset:0
    ds_read_b64_tr_b16 v[18:19], v8 offset:512
    v_mfma_f32_16x16x32_bf16 v[88:91], v[20:23], v[40:43], v[88:91]
    v_mfma_f32_16x16x32_bf16 v[92:95], v[20:23], v[44:47], v[92:95]
    ds_read_b64_tr_b16 v[20:21], v9 offset:0
    ds_read_b64_tr_b16 v[22:23], v9 offset:512
    v_mfma_f32_16x16x32_bf16 v[104:107], v[24:27], v[40:43], v[104:107]
    v_mfma_f32_16x16x32_bf16 v[108:111], v[24:27], v[44:47], v[108:111]
    ds_read_b64_tr_b16 v[24:25], v10 offset:0
    ds_read_b64_tr_b16 v[26:27], v10 offset:512
    v_mfma_f32_16x16x32_bf16 v[120:123], v[28:31], v[40:43], v[120:123]
    ds_read_b128 v[40:43], v62 offset:12288
    v_mfma_f32_16x16x32_bf16 v[124:127], v[28:31], v[44:47], v[124:127]
    ds_read_b64_tr_b16 v[28:29], v11 offset:0
    ds_read_b64_tr_b16 v[30:31], v11 offset:512
    s_waitcnt lgkmcnt(7)
    v_mfma_f32_16x16x32_bf16 v[64:67], v[16:19], v[32:35], v[64:67]
    ds_read_b128 v[44:47], v62 offset:14336
    v_mfma_f32_16x16x32_bf16 v[68:71], v[16:19], v[36:39], v[68:71]
    s_waitcnt lgkmcnt(6)
    v_mfma_f32_16x16x32_bf16 v[80:83], v[20:23], v[32:35], v[80:83]
    v_mfma_f32_16x16x32_bf16 v[84:87], v[20:23], v[36:39], v[84:87]
    s_waitcnt lgkmcnt(4)
    v_mfma_f32_16x16x32_bf16 v[96:99], v[24:27], v[32:35], v[96:99]
    v_mfma_f32_16x16x32_bf16 v[100:103], v[24:27], v[36:39], v[100:103]
    s_barrier
    s_waitcnt lgkmcnt(1)
    v_mfma_f32_16x16x32_bf16 v[112:115], v[28:31], v[32:35], v[112:115]
    ds_read_b128 v[32:35], v63 offset:8192
    v_mfma_f32_16x16x32_bf16 v[116:119], v[28:31], v[36:39], v[116:119]
    ds_read_b128 v[36:39], v63 offset:10240
    v_mfma_f32_16x16x32_bf16 v[72:75], v[16:19], v[40:43], v[72:75]
    s_waitcnt lgkmcnt(2)
    v_mfma_f32_16x16x32_bf16 v[76:79], v[16:19], v[44:47], v[76:79]
    v_add_u32 v8, 0x1c000, v4
    v_xor_b32 v9, 32, v8
    v_xor_b32 v10, 64, v8
    v_xor_b32 v11, 96, v8
    ds_read_b64_tr_b16 v[16:17], v8 offset:0
    ds_read_b64_tr_b16 v[18:19], v8 offset:512
    v_mfma_f32_16x16x32_bf16 v[88:91], v[20:23], v[40:43], v[88:91]
    v_mfma_f32_16x16x32_bf16 v[92:95], v[20:23], v[44:47], v[92:95]
    ds_read_b64_tr_b16 v[20:21], v9 offset:0
    ds_read_b64_tr_b16 v[22:23], v9 offset:512
    v_mfma_f32_16x16x32_bf16 v[104:107], v[24:27], v[40:43], v[104:107]
    v_mfma_f32_16x16x32_bf16 v[108:111], v[24:27], v[44:47], v[108:111]
    ds_read_b64_tr_b16 v[24:25], v10 offset:0
    ds_read_b64_tr_b16 v[26:27], v10 offset:512
    v_mfma_f32_16x16x32_bf16 v[120:123], v[28:31], v[40:43], v[120:123]
    ds_read_b128 v[40:43], v63 offset:12288
    v_mfma_f32_16x16x32_bf16 v[124:127], v[28:31], v[44:47], v[124:127]
    ds_read_b64_tr_b16 v[28:29], v11 offset:0
    ds_read_b64_tr_b16 v[30:31], v11 offset:512
    s_waitcnt lgkmcnt(7)
    v_mfma_f32_16x16x32_bf16 v[64:67], v[16:19], v[32:35], v[64:67]
    ds_read_b128 v[44:47], v63 offset:14336
    v_mfma_f32_16x16x32_bf16 v[68:71], v[16:19], v[36:39], v[68:71]
    s_waitcnt lgkmcnt(6)
    v_mfma_f32_16x16x32_bf16 v[80:83], v[20:23], v[32:35], v[80:83]
    v_mfma_f32_16x16x32_bf16 v[84:87], v[20:23], v[36:39], v[84:87]
    s_waitcnt lgkmcnt(4)
    v_mfma_f32_16x16x32_bf16 v[96:99], v[24:27], v[32:35], v[96:99]
    v_mfma_f32_16x16x32_bf16 v[100:103], v[24:27], v[36:39], v[100:103]
    s_barrier
    s_waitcnt lgkmcnt(1)
    v_mfma_f32_16x16x32_bf16 v[112:115], v[28:31], v[32:35], v[112:115]
    ds_read_b128 v[32:35], v62 offset:16384
    v_mfma_f32_16x16x32_bf16 v[116:119], v[28:31], v[36:39], v[116:119]
    ds_read_b128 v[36:39], v62 offset:18432
    v_mfma_f32_16x16x32_bf16 v[72:75], v[16:19], v[40:43], v[72:75]
    s_waitcnt lgkmcnt(2)
    v_mfma_f32_16x16x32_bf16 v[76:79], v[16:19], v[44:47], v[76:79]
    v_add_u32 v8, 0x8000, v4
    v_xor_b32 v9, 32, v8
    v_xor_b32 v10, 64, v8
    v_xor_b32 v11, 96, v8
    ds_read_b64_tr_b16 v[16:17], v8 offset:0
    ds_read_b64_tr_b16 v[18:19], v8 offset:512
    v_mfma_f32_16x16x32_bf16 v[88:91], v[20:23], v[40:43], v[88:91]
    v_mfma_f32_16x16x32_bf16 v[92:95], v[20:23], v[44:47], v[92:95]
    ds_read_b64_tr_b16 v[20:21], v9 offset:0
    ds_read_b64_tr_b16 v[22:23], v9 offset:512
    v_mfma_f32_16x16x32_bf16 v[104:107], v[24:27], v[40:43], v[104:107]
    v_mfma_f32_16x16x32_bf16 v[108:111], v[24:27], v[44:47], v[108:111]
    ds_read_b64_tr_b16 v[24:25], v10 offset:0
    ds_read_b64_tr_b16 v[26:27], v10 offset:512
    v_mfma_f32_16x16x32_bf16 v[120:123], v[28:31], v[40:43], v[120:123]
    ds_read_b128 v[40:43], v62 offset:20480
    v_mfma_f32_16x16x32_bf16 v[124:127], v[28:31], v[44:47], v[124:127]
    ds_read_b64_tr_b16 v[28:29], v11 offset:0
    ds_read_b64_tr_b16 v[30:31], v11 offset:512
    s_waitcnt lgkmcnt(7)
    v_mfma_f32_16x16x32_bf16 v[64:67], v[16:19], v[32:35], v[64:67]
    ds_read_b128 v[44:47], v62 offset:22528
    v_mfma_f32_16x16x32_bf16 v[68:71], v[16:19], v[36:39], v[68:71]
    s_waitcnt lgkmcnt(6)
    v_mfma_f32_16x16x32_bf16 v[80:83], v[20:23], v[32:35], v[80:83]
    v_mfma_f32_16x16x32_bf16 v[84:87], v[20:23], v[36:39], v[84:87]
    s_waitcnt lgkmcnt(4)
    v_mfma_f32_16x16x32_bf16 v[96:99], v[24:27], v[32:35], v[96:99]
    v_mfma_f32_16x16x32_bf16 v[100:103], v[24:27], v[36:39], v[100:103]
    s_barrier
    s_waitcnt lgkmcnt(1)
    v_mfma_f32_16x16x32_bf16 v[112:115], v[28:31], v[32:35], v[112:115]
    ds_read_b128 v[32:35], v63 offset:16384
    v_mfma_f32_16x16x32_bf16 v[116:119], v[28:31], v[36:39], v[116:119]
    ds_read_b128 v[36:39], v63 offset:18432
    v_mfma_f32_16x16x32_bf16 v[72:75], v[16:19], v[40:43], v[72:75]
    s_waitcnt lgkmcnt(2)
    v_mfma_f32_16x16x32_bf16 v[76:79], v[16:19], v[44:47], v[76:79]
    v_add_u32 v8, 0xc000, v4
    v_xor_b32 v9, 32, v8
    v_xor_b32 v10, 64, v8
    v_xor_b32 v11, 96, v8
    ds_read_b64_tr_b16 v[16:17], v8 offset:0
    ds_read_b64_tr_b16 v[18:19], v8 offset:512
    v_mfma_f32_16x16x32_bf16 v[88:91], v[20:23], v[40:43], v[88:91]
    v_mfma_f32_16x16x32_bf16 v[92:95], v[20:23], v[44:47], v[92:95]
    ds_read_b64_tr_b16 v[20:21], v9 offset:0
    ds_read_b64_tr_b16 v[22:23], v9 offset:512
    v_mfma_f32_16x16x32_bf16 v[104:107], v[24:27], v[40:43], v[104:107]
    v_mfma_f32_16x16x32_bf16 v[108:111], v[24:27], v[44:47], v[108:111]
    ds_read_b64_tr_b16 v[24:25], v10 offset:0
    ds_read_b64_tr_b16 v[26:27], v10 offset:512
    v_mfma_f32_16x16x32_bf16 v[120:123], v[28:31], v[40:43], v[120:123]
    ds_read_b128 v[40:43], v63 offset:20480
    v_mfma_f32_16x16x32_bf16 v[124:127], v[28:31], v[44:47], v[124:127]
    ds_read_b64_tr_b16 v[28:29], v11 offset:0
    ds_read_b64_tr_b16 v[30:31], v11 offset:512
    s_waitcnt lgkmcnt(7)
    v_mfma_f32_16x16x32_bf16 v[64:67], v[16:19], v[32:35], v[64:67]
    ds_read_b128 v[44:47], v63 offset:22528
    v_mfma_f32_16x16x32_bf16 v[68:71], v[16:19], v[36:39], v[68:71]
    s_waitcnt lgkmcnt(6)
    v_mfma_f32_16x16x32_bf16 v[80:83], v[20:23], v[32:35], v[80:83]
    v_mfma_f32_16x16x32_bf16 v[84:87], v[20:23], v[36:39], v[84:87]
    s_waitcnt lgkmcnt(4)
    v_mfma_f32_16x16x32_bf16 v[96:99], v[24:27], v[32:35], v[96:99]
    v_mfma_f32_16x16x32_bf16 v[100:103], v[24:27], v[36:39], v[100:103]
    s_waitcnt lgkmcnt(0)
    s_barrier
    v_mfma_f32_16x16x32_bf16 v[112:115], v[28:31], v[32:35], v[112:115]
    v_mfma_f32_16x16x32_bf16 v[116:119], v[28:31], v[36:39], v[116:119]
    v_mfma_f32_16x16x32_bf16 v[72:75], v[16:19], v[40:43], v[72:75]
    v_mfma_f32_16x16x32_bf16 v[76:79], v[16:19], v[44:47], v[76:79]
    v_mfma_f32_16x16x32_bf16 v[88:91], v[20:23], v[40:43], v[88:91]
    v_mfma_f32_16x16x32_bf16 v[92:95], v[20:23], v[44:47], v[92:95]
    v_mfma_f32_16x16x32_bf16 v[104:107], v[24:27], v[40:43], v[104:107]
    v_mfma_f32_16x16x32_bf16 v[108:111], v[24:27], v[44:47], v[108:111]
    v_mfma_f32_16x16x32_bf16 v[120:123], v[28:31], v[40:43], v[120:123]
    v_mfma_f32_16x16x32_bf16 v[124:127], v[28:31], v[44:47], v[124:127]
    s_nop 7
    s_nop 1
    v_cvt_pk_bf16_f32 v64, v64, v65
    v_cvt_pk_bf16_f32 v65, v66, v67
    ds_write_b64 v61, v[64:65] offset:0
    v_cvt_pk_bf16_f32 v68, v68, v69
    v_cvt_pk_bf16_f32 v69, v70, v71
    ds_write_b64 v61, v[68:69] offset:1024
    v_cvt_pk_bf16_f32 v72, v72, v73
    v_cvt_pk_bf16_f32 v73, v74, v75
    ds_write_b64 v61, v[72:73] offset:2048
    v_cvt_pk_bf16_f32 v76, v76, v77
    v_cvt_pk_bf16_f32 v77, v78, v79
    ds_write_b64 v61, v[76:77] offset:3072
    v_cvt_pk_bf16_f32 v80, v80, v81
    v_cvt_pk_bf16_f32 v81, v82, v83
    ds_write_b64 v61, v[80:81] offset:512
    v_cvt_pk_bf16_f32 v84, v84, v85
    v_cvt_pk_bf16_f32 v85, v86, v87
    ds_write_b64 v61, v[84:85] offset:1536
    v_cvt_pk_bf16_f32 v88, v88, v89
    v_cvt_pk_bf16_f32 v89, v90, v91
    ds_write_b64 v61, v[88:89] offset:2560
    v_cvt_pk_bf16_f32 v92, v92, v93
    v_cvt_pk_bf16_f32 v93, v94, v95
    ds_write_b64 v61, v[92:93] offset:3584
    v_cvt_pk_bf16_f32 v96, v96, v97
    v_cvt_pk_bf16_f32 v97, v98, v99
    ds_write_b64 v61, v[96:97] offset:4096
    v_cvt_pk_bf16_f32 v100, v100, v101
    v_cvt_pk_bf16_f32 v101, v102, v103
    ds_write_b64 v61, v[100:101] offset:5120
    v_cvt_pk_bf16_f32 v104, v104, v105
    v_cvt_pk_bf16_f32 v105, v106, v107
    ds_write_b64 v61, v[104:105] offset:6144
    v_cvt_pk_bf16_f32 v108, v108, v109
    v_cvt_pk_bf16_f32 v109, v110, v111
    ds_write_b64 v61, v[108:109] offset:7168
    v_cvt_pk_bf16_f32 v112, v112, v113
    v_cvt_pk_bf16_f32 v113, v114, v115
    ds_write_b64 v61, v[112:113] offset:4608
    v_cvt_pk_bf16_f32 v116, v116, v117
    v_cvt_pk_bf16_f32 v117, v118, v119
    ds_write_b64 v61, v[116:117] offset:5632
    v_cvt_pk_bf16_f32 v120, v120, v121
    v_cvt_pk_bf16_f32 v121, v122, v123
    ds_write_b64 v61, v[120:121] offset:6656
    v_cvt_pk_bf16_f32 v124, v124, v125
    v_cvt_pk_bf16_f32 v125, v126, v127
    ds_write_b64 v61, v[124:125] offset:7680
    s_waitcnt lgkmcnt(0)
    s_barrier
    v_add_u32 v8, 0x10000, v56
    v_add_u32 v9, 0x10000, v57
    ds_read_b128 v[16:19], v8 offset:0
    ds_read_b128 v[64:67], v2 offset:0
    ds_read_b128 v[68:71], v2 offset:1024
    ds_read_b128 v[72:75], v2 offset:2048
    ds_read_b128 v[76:79], v2 offset:3072
    ds_read_b128 v[20:23], v8 offset:2048
    ds_read_b128 v[24:27], v9 offset:0
    ds_read_b128 v[80:83], v2 offset:4096
    ds_read_b128 v[84:87], v2 offset:5120
    ds_read_b128 v[88:91], v2 offset:6144
    ds_read_b128 v[92:95], v2 offset:7168
    ds_read_b128 v[28:31], v9 offset:2048
    s_waitcnt lgkmcnt(10)
    v_mfma_f32_16x16x32_bf16 v[128:131], v[16:19], v[64:67], 0
    s_waitcnt lgkmcnt(9)
    v_mfma_f32_16x16x32_bf16 v[132:135], v[16:19], v[68:71], 0
    s_waitcnt lgkmcnt(8)
    v_mfma_f32_16x16x32_bf16 v[136:139], v[16:19], v[72:75], 0
    s_barrier
    s_waitcnt lgkmcnt(7)
    v_mfma_f32_16x16x32_bf16 v[140:143], v[16:19], v[76:79], 0
    v_add_u32 v8, 0x14000, v56
    v_add_u32 v9, 0x14000, v57
    ds_read_b128 v[16:19], v8 offset:0
    s_waitcnt lgkmcnt(7)
    v_mfma_f32_16x16x32_bf16 v[144:147], v[20:23], v[64:67], 0
    v_mfma_f32_16x16x32_bf16 v[148:151], v[20:23], v[68:71], 0
    v_mfma_f32_16x16x32_bf16 v[152:155], v[20:23], v[72:75], 0
    v_mfma_f32_16x16x32_bf16 v[156:159], v[20:23], v[76:79], 0
    ds_read_b128 v[20:23], v8 offset:2048
    s_waitcnt lgkmcnt(6)
    v_mfma_f32_16x16x32_bf16 v[128:131], v[24:27], v[80:83], v[128:131]
    s_waitcnt lgkmcnt(5)
    v_mfma_f32_16x16x32_bf16 v[132:135], v[24:27], v[84:87], v[132:135]
    s_waitcnt lgkmcnt(4)
    v_mfma_f32_16x16x32_bf16 v[136:139], v[24:27], v[88:91], v[136:139]
    s_waitcnt lgkmcnt(3)
    v_mfma_f32_16x16x32_bf16 v[140:143], v[24:27], v[92:95], v[140:143]
    ds_read_b128 v[24:27], v9 offset:0
    s_waitcnt lgkmcnt(3)
    v_mfma_f32_16x16x32_bf16 v[144:147], v[28:31], v[80:83], v[144:147]
    v_mfma_f32_16x16x32_bf16 v[148:151], v[28:31], v[84:87], v[148:151]
    v_mfma_f32_16x16x32_bf16 v[152:155], v[28:31], v[88:91], v[152:155]
    v_mfma_f32_16x16x32_bf16 v[156:159], v[28:31], v[92:95], v[156:159]
    ds_read_b128 v[28:31], v9 offset:2048
    s_waitcnt lgkmcnt(3)
    v_mfma_f32_16x16x32_bf16 v[160:163], v[16:19], v[64:67], 0
    v_mfma_f32_16x16x32_bf16 v[164:167], v[16:19], v[68:71], 0
    v_mfma_f32_16x16x32_bf16 v[168:171], v[16:19], v[72:75], 0
    s_barrier
    v_mfma_f32_16x16x32_bf16 v[172:175], v[16:19], v[76:79], 0
    v_add_u32 v8, 0x18000, v56
    v_add_u32 v9, 0x18000, v57
    ds_read_b128 v[16:19], v8 offset:0
    s_waitcnt lgkmcnt(3)
    v_mfma_f32_16x16x32_bf16 v[176:179], v[20:23], v[64:67], 0
    ds_read_b128 v[64:67], v2 offset:8192
    v_mfma_f32_16x16x32_bf16 v[180:183], v[20:23], v[68:71], 0
    ds_read_b128 v[68:71], v2 offset:9216
    v_mfma_f32_16x16x32_bf16 v[184:187], v[20:23], v[72:75], 0
    ds_read_b128 v[72:75], v2 offset:10240
    v_mfma_f32_16x16x32_bf16 v[188:191], v[20:23], v[76:79], 0
    ds_read_b128 v[76:79], v2 offset:11264
    ds_read_b128 v[20:23], v8 offset:2048
    s_waitcnt lgkmcnt(7)
    v_mfma_f32_16x16x32_bf16 v[160:163], v[24:27], v[80:83], v[160:163]
    v_mfma_f32_16x16x32_bf16 v[164:167], v[24:27], v[84:87], v[164:167]
    v_mfma_f32_16x16x32_bf16 v[168:171], v[24:27], v[88:91], v[168:171]
    v_mfma_f32_16x16x32_bf16 v[172:175], v[24:27], v[92:95], v[172:175]
    ds_read_b128 v[24:27], v9 offset:0
    s_waitcnt lgkmcnt(7)
    v_mfma_f32_16x16x32_bf16 v[176:179], v[28:31], v[80:83], v[176:179]
    ds_read_b128 v[80:83], v2 offset:12288
    v_mfma_f32_16x16x32_bf16 v[180:183], v[28:31], v[84:87], v[180:183]
    ds_read_b128 v[84:87], v2 offset:13312
    v_mfma_f32_16x16x32_bf16 v[184:187], v[28:31], v[88:91], v[184:187]
    ds_read_b128 v[88:91], v2 offset:14336
    v_mfma_f32_16x16x32_bf16 v[188:191], v[28:31], v[92:95], v[188:191]
    ds_read_b128 v[92:95], v2 offset:15360
    ds_read_b128 v[28:31], v9 offset:2048
    s_waitcnt lgkmcnt(10)
    v_mfma_f32_16x16x32_bf16 v[128:131], v[16:19], v[64:67], v[128:131]
    s_waitcnt lgkmcnt(9)
    v_mfma_f32_16x16x32_bf16 v[132:135], v[16:19], v[68:71], v[132:135]
    s_waitcnt lgkmcnt(8)
    v_mfma_f32_16x16x32_bf16 v[136:139], v[16:19], v[72:75], v[136:139]
    s_barrier
    s_waitcnt lgkmcnt(7)
    v_mfma_f32_16x16x32_bf16 v[140:143], v[16:19], v[76:79], v[140:143]
    v_add_u32 v8, 0x1c000, v56
    v_add_u32 v9, 0x1c000, v57
    ds_read_b128 v[16:19], v8 offset:0
    s_waitcnt lgkmcnt(7)
    v_mfma_f32_16x16x32_bf16 v[144:147], v[20:23], v[64:67], v[144:147]
    v_mfma_f32_16x16x32_bf16 v[148:151], v[20:23], v[68:71], v[148:151]
    v_mfma_f32_16x16x32_bf16 v[152:155], v[20:23], v[72:75], v[152:155]
    v_mfma_f32_16x16x32_bf16 v[156:159], v[20:23], v[76:79], v[156:159]
    ds_read_b128 v[20:23], v8 offset:2048
    s_waitcnt lgkmcnt(6)
    v_mfma_f32_16x16x32_bf16 v[128:131], v[24:27], v[80:83], v[128:131]
    s_waitcnt lgkmcnt(5)
    v_mfma_f32_16x16x32_bf16 v[132:135], v[24:27], v[84:87], v[132:135]
    s_waitcnt lgkmcnt(4)
    v_mfma_f32_16x16x32_bf16 v[136:139], v[24:27], v[88:91], v[136:139]
    s_waitcnt lgkmcnt(3)
    v_mfma_f32_16x16x32_bf16 v[140:143], v[24:27], v[92:95], v[140:143]
    ds_read_b128 v[24:27], v9 offset:0
    v_bfe_u32 v3, v0, 2, 2
    s_waitcnt lgkmcnt(3)
    v_mfma_f32_16x16x32_bf16 v[144:147], v[28:31], v[80:83], v[144:147]
    v_mfma_f32_16x16x32_bf16 v[148:151], v[28:31], v[84:87], v[148:151]
    v_mfma_f32_16x16x32_bf16 v[152:155], v[28:31], v[88:91], v[152:155]
    v_mfma_f32_16x16x32_bf16 v[156:159], v[28:31], v[92:95], v[156:159]
    ds_read_b128 v[28:31], v9 offset:2048
    s_waitcnt lgkmcnt(3)
    v_mfma_f32_16x16x32_bf16 v[160:163], v[16:19], v[64:67], v[160:163]
    v_mfma_f32_16x16x32_bf16 v[164:167], v[16:19], v[68:71], v[164:167]
    v_mfma_f32_16x16x32_bf16 v[168:171], v[16:19], v[72:75], v[168:171]
    s_barrier
    v_mfma_f32_16x16x32_bf16 v[172:175], v[16:19], v[76:79], v[172:175]
    v_add_u32 v8, 0x8000, v56
    v_add_u32 v9, 0x8000, v57
    ds_read_b128 v[16:19], v8 offset:0
    s_waitcnt lgkmcnt(3)
    v_mfma_f32_16x16x32_bf16 v[176:179], v[20:23], v[64:67], v[176:179]
    ds_read_b128 v[64:67], v2 offset:16384
    v_lshlrev_b32 v3, 7, v3
    v_mfma_f32_16x16x32_bf16 v[180:183], v[20:23], v[68:71], v[180:183]
    ds_read_b128 v[68:71], v2 offset:17408
    v_mfma_f32_16x16x32_bf16 v[184:187], v[20:23], v[72:75], v[184:187]
    ds_read_b128 v[72:75], v2 offset:18432
    v_mfma_f32_16x16x32_bf16 v[188:191], v[20:23], v[76:79], v[188:191]
    ds_read_b128 v[76:79], v2 offset:19456
    ds_read_b128 v[20:23], v8 offset:2048
    s_waitcnt lgkmcnt(7)
    v_mfma_f32_16x16x32_bf16 v[160:163], v[24:27], v[80:83], v[160:163]
    v_mfma_f32_16x16x32_bf16 v[164:167], v[24:27], v[84:87], v[164:167]
    v_mfma_f32_16x16x32_bf16 v[168:171], v[24:27], v[88:91], v[168:171]
    v_lshrrev_b32 v1, 4, v0
    v_mfma_f32_16x16x32_bf16 v[172:175], v[24:27], v[92:95], v[172:175]
    ds_read_b128 v[24:27], v9 offset:0
    s_waitcnt lgkmcnt(7)
    v_mfma_f32_16x16x32_bf16 v[176:179], v[28:31], v[80:83], v[176:179]
    ds_read_b128 v[80:83], v2 offset:20480
    v_mfma_f32_16x16x32_bf16 v[180:183], v[28:31], v[84:87], v[180:183]
    ds_read_b128 v[84:87], v2 offset:21504
    v_mfma_f32_16x16x32_bf16 v[184:187], v[28:31], v[88:91], v[184:187]
    ds_read_b128 v[88:91], v2 offset:22528
    v_mfma_f32_16x16x32_bf16 v[188:191], v[28:31], v[92:95], v[188:191]
    ds_read_b128 v[92:95], v2 offset:23552
    ds_read_b128 v[28:31], v9 offset:2048
    s_waitcnt lgkmcnt(10)
    v_mfma_f32_16x16x32_bf16 v[128:131], v[16:19], v[64:67], v[128:131]
    s_waitcnt lgkmcnt(9)
    v_mfma_f32_16x16x32_bf16 v[132:135], v[16:19], v[68:71], v[132:135]
    v_lshl_add_u32 v3, v1, 9, v3
    s_waitcnt lgkmcnt(8)
    v_mfma_f32_16x16x32_bf16 v[136:139], v[16:19], v[72:75], v[136:139]
    s_barrier
    s_waitcnt lgkmcnt(7)
    v_mfma_f32_16x16x32_bf16 v[140:143], v[16:19], v[76:79], v[140:143]
    v_add_u32 v8, 0xc000, v56
    v_add_u32 v9, 0xc000, v57
    ds_read_b128 v[16:19], v8 offset:0
    s_waitcnt lgkmcnt(7)
    v_mfma_f32_16x16x32_bf16 v[144:147], v[20:23], v[64:67], v[144:147]
    v_mfma_f32_16x16x32_bf16 v[148:151], v[20:23], v[68:71], v[148:151]
    v_mfma_f32_16x16x32_bf16 v[152:155], v[20:23], v[72:75], v[152:155]
    v_mfma_f32_16x16x32_bf16 v[156:159], v[20:23], v[76:79], v[156:159]
    ds_read_b128 v[20:23], v8 offset:2048
    s_waitcnt lgkmcnt(6)
    v_mfma_f32_16x16x32_bf16 v[128:131], v[24:27], v[80:83], v[128:131]
    s_waitcnt lgkmcnt(5)
    v_mfma_f32_16x16x32_bf16 v[132:135], v[24:27], v[84:87], v[132:135]
    v_and_b32 v1, 3, v0
    s_waitcnt lgkmcnt(4)
    v_mfma_f32_16x16x32_bf16 v[136:139], v[24:27], v[88:91], v[136:139]
    s_waitcnt lgkmcnt(3)
    v_mfma_f32_16x16x32_bf16 v[140:143], v[24:27], v[92:95], v[140:143]
    ds_read_b128 v[24:27], v9 offset:0
    s_waitcnt lgkmcnt(3)
    v_mfma_f32_16x16x32_bf16 v[144:147], v[28:31], v[80:83], v[144:147]
    v_mfma_f32_16x16x32_bf16 v[148:151], v[28:31], v[84:87], v[148:151]
    v_mfma_f32_16x16x32_bf16 v[152:155], v[28:31], v[88:91], v[152:155]
    v_mfma_f32_16x16x32_bf16 v[156:159], v[28:31], v[92:95], v[156:159]
    ds_read_b128 v[28:31], v9 offset:2048
    s_waitcnt lgkmcnt(3)
    v_mfma_f32_16x16x32_bf16 v[160:163], v[16:19], v[64:67], v[160:163]
    v_mfma_f32_16x16x32_bf16 v[164:167], v[16:19], v[68:71], v[164:167]
    v_lshl_add_u32 v3, v1, 3, v3
    v_mfma_f32_16x16x32_bf16 v[168:171], v[16:19], v[72:75], v[168:171]
    s_barrier
    v_mfma_f32_16x16x32_bf16 v[172:175], v[16:19], v[76:79], v[172:175]
    v_add_u32 v8, 0x20000, v56
    v_add_u32 v9, 0x20000, v57
    ds_read_b128 v[16:19], v8 offset:0
    s_waitcnt lgkmcnt(3)
    v_mfma_f32_16x16x32_bf16 v[176:179], v[20:23], v[64:67], v[176:179]
    ds_read_b128 v[64:67], v2 offset:24576
    v_mfma_f32_16x16x32_bf16 v[180:183], v[20:23], v[68:71], v[180:183]
    ds_read_b128 v[68:71], v2 offset:25600
    v_mfma_f32_16x16x32_bf16 v[184:187], v[20:23], v[72:75], v[184:187]
    ds_read_b128 v[72:75], v2 offset:26624
    v_mfma_f32_16x16x32_bf16 v[188:191], v[20:23], v[76:79], v[188:191]
    ds_read_b128 v[76:79], v2 offset:27648
    ds_read_b128 v[20:23], v8 offset:2048
    s_waitcnt lgkmcnt(7)
    v_mfma_f32_16x16x32_bf16 v[160:163], v[24:27], v[80:83], v[160:163]
    v_bfe_u32 v1, v0, 3, 2
    v_mfma_f32_16x16x32_bf16 v[164:167], v[24:27], v[84:87], v[164:167]
    v_mfma_f32_16x16x32_bf16 v[168:171], v[24:27], v[88:91], v[168:171]
    v_mfma_f32_16x16x32_bf16 v[172:175], v[24:27], v[92:95], v[172:175]
    ds_read_b128 v[24:27], v9 offset:0
    s_waitcnt lgkmcnt(7)
    v_mfma_f32_16x16x32_bf16 v[176:179], v[28:31], v[80:83], v[176:179]
    ds_read_b128 v[80:83], v2 offset:28672
    v_mfma_f32_16x16x32_bf16 v[180:183], v[28:31], v[84:87], v[180:183]
    ds_read_b128 v[84:87], v2 offset:29696
    v_mfma_f32_16x16x32_bf16 v[184:187], v[28:31], v[88:91], v[184:187]
    ds_read_b128 v[88:91], v2 offset:30720
    v_mfma_f32_16x16x32_bf16 v[188:191], v[28:31], v[92:95], v[188:191]
    ds_read_b128 v[92:95], v2 offset:31744
    ds_read_b128 v[28:31], v9 offset:2048
    s_waitcnt lgkmcnt(10)
    v_mfma_f32_16x16x32_bf16 v[128:131], v[16:19], v[64:67], v[128:131]
    v_lshl_add_u32 v4, v1, 5, v3
    s_waitcnt lgkmcnt(9)
    v_mfma_f32_16x16x32_bf16 v[132:135], v[16:19], v[68:71], v[132:135]
    s_waitcnt lgkmcnt(8)
    v_mfma_f32_16x16x32_bf16 v[136:139], v[16:19], v[72:75], v[136:139]
    s_barrier
    s_waitcnt lgkmcnt(7)
    v_mfma_f32_16x16x32_bf16 v[140:143], v[16:19], v[76:79], v[140:143]
    v_add_u32 v8, 0x24000, v56
    v_add_u32 v9, 0x24000, v57
    ds_read_b128 v[16:19], v8 offset:0
    s_waitcnt lgkmcnt(7)
    v_mfma_f32_16x16x32_bf16 v[144:147], v[20:23], v[64:67], v[144:147]
    v_mfma_f32_16x16x32_bf16 v[148:151], v[20:23], v[68:71], v[148:151]
    s_lshl_b32 s50, s3, 12
    v_mfma_f32_16x16x32_bf16 v[152:155], v[20:23], v[72:75], v[152:155]
    v_mfma_f32_16x16x32_bf16 v[156:159], v[20:23], v[76:79], v[156:159]
    ds_read_b128 v[20:23], v8 offset:2048
    s_waitcnt lgkmcnt(6)
    v_mfma_f32_16x16x32_bf16 v[128:131], v[24:27], v[80:83], v[128:131]
    s_waitcnt lgkmcnt(5)
    v_mfma_f32_16x16x32_bf16 v[132:135], v[24:27], v[84:87], v[132:135]
    s_waitcnt lgkmcnt(4)
    v_mfma_f32_16x16x32_bf16 v[136:139], v[24:27], v[88:91], v[136:139]
    v_add_u32 v4, s50, v4
    s_waitcnt lgkmcnt(3)
    v_mfma_f32_16x16x32_bf16 v[140:143], v[24:27], v[92:95], v[140:143]
    ds_read_b128 v[24:27], v9 offset:0
    s_waitcnt lgkmcnt(3)
    v_mfma_f32_16x16x32_bf16 v[144:147], v[28:31], v[80:83], v[144:147]
    v_mfma_f32_16x16x32_bf16 v[148:151], v[28:31], v[84:87], v[148:151]
    v_mfma_f32_16x16x32_bf16 v[152:155], v[28:31], v[88:91], v[152:155]
    v_mfma_f32_16x16x32_bf16 v[156:159], v[28:31], v[92:95], v[156:159]
    ds_read_b128 v[28:31], v9 offset:2048
    s_waitcnt lgkmcnt(3)
    v_mfma_f32_16x16x32_bf16 v[160:163], v[16:19], v[64:67], v[160:163]
    v_mfma_f32_16x16x32_bf16 v[164:167], v[16:19], v[68:71], v[164:167]
    v_mfma_f32_16x16x32_bf16 v[168:171], v[16:19], v[72:75], v[168:171]
    s_barrier
    v_mfma_f32_16x16x32_bf16 v[172:175], v[16:19], v[76:79], v[172:175]
    v_add_u32 v8, 0x10000, v56
    v_add_u32 v9, 0x10000, v57
    ds_read_b128 v[16:19], v8 offset:0
    s_waitcnt lgkmcnt(3)
    v_mfma_f32_16x16x32_bf16 v[176:179], v[20:23], v[64:67], v[176:179]
    ds_read_b128 v[64:67], v2 offset:0
    v_mfma_f32_16x16x32_bf16 v[180:183], v[20:23], v[68:71], v[180:183]
    ds_read_b128 v[68:71], v2 offset:1024
    v_mfma_f32_16x16x32_bf16 v[184:187], v[20:23], v[72:75], v[184:187]
    ds_read_b128 v[72:75], v2 offset:2048
    v_mfma_f32_16x16x32_bf16 v[188:191], v[20:23], v[76:79], v[188:191]
    ds_read_b128 v[76:79], v2 offset:3072
    ds_read_b128 v[20:23], v8 offset:2048
    s_waitcnt lgkmcnt(7)
    v_mfma_f32_16x16x32_bf16 v[160:163], v[24:27], v[80:83], v[160:163]
    v_mfma_f32_16x16x32_bf16 v[164:167], v[24:27], v[84:87], v[164:167]
    v_mfma_f32_16x16x32_bf16 v[168:171], v[24:27], v[88:91], v[168:171]
    v_mfma_f32_16x16x32_bf16 v[172:175], v[24:27], v[92:95], v[172:175]
    ds_read_b128 v[24:27], v9 offset:0
    s_waitcnt lgkmcnt(7)
    v_mfma_f32_16x16x32_bf16 v[176:179], v[28:31], v[80:83], v[176:179]
    ds_read_b128 v[80:83], v2 offset:4096
    v_mfma_f32_16x16x32_bf16 v[180:183], v[28:31], v[84:87], v[180:183]
    ds_read_b128 v[84:87], v2 offset:5120
    v_mfma_f32_16x16x32_bf16 v[184:187], v[28:31], v[88:91], v[184:187]
    ds_read_b128 v[88:91], v2 offset:6144
    v_mfma_f32_16x16x32_bf16 v[188:191], v[28:31], v[92:95], v[188:191]
    ds_read_b128 v[92:95], v2 offset:7168
    ds_read_b128 v[28:31], v9 offset:2048
    s_waitcnt lgkmcnt(10)
    v_mfma_f32_16x16x32_bf16 v[192:195], v[16:19], v[64:67], 0
    s_waitcnt lgkmcnt(9)
    v_mfma_f32_16x16x32_bf16 v[196:199], v[16:19], v[68:71], 0
    s_waitcnt lgkmcnt(8)
    v_mfma_f32_16x16x32_bf16 v[200:203], v[16:19], v[72:75], 0
    s_barrier
    s_waitcnt lgkmcnt(7)
    v_mfma_f32_16x16x32_bf16 v[204:207], v[16:19], v[76:79], 0
    v_add_u32 v8, 0x14000, v56
    v_add_u32 v9, 0x14000, v57
    ds_read_b128 v[16:19], v8 offset:0
    s_waitcnt lgkmcnt(7)
    v_mfma_f32_16x16x32_bf16 v[208:211], v[20:23], v[64:67], 0
    v_mfma_f32_16x16x32_bf16 v[212:215], v[20:23], v[68:71], 0
    v_mfma_f32_16x16x32_bf16 v[216:219], v[20:23], v[72:75], 0
    v_mfma_f32_16x16x32_bf16 v[220:223], v[20:23], v[76:79], 0
    ds_read_b128 v[20:23], v8 offset:2048
    s_waitcnt lgkmcnt(6)
    v_mfma_f32_16x16x32_bf16 v[192:195], v[24:27], v[80:83], v[192:195]
    s_waitcnt lgkmcnt(5)
    v_mfma_f32_16x16x32_bf16 v[196:199], v[24:27], v[84:87], v[196:199]
    s_waitcnt lgkmcnt(4)
    v_mfma_f32_16x16x32_bf16 v[200:203], v[24:27], v[88:91], v[200:203]
    s_waitcnt lgkmcnt(3)
    v_mfma_f32_16x16x32_bf16 v[204:207], v[24:27], v[92:95], v[204:207]
    ds_read_b128 v[24:27], v9 offset:0
    v_max3_f32 v48, v128, v129, v130
    s_waitcnt lgkmcnt(3)
    v_mfma_f32_16x16x32_bf16 v[208:211], v[28:31], v[80:83], v[208:211]
    v_mfma_f32_16x16x32_bf16 v[212:215], v[28:31], v[84:87], v[212:215]
    v_max3_f32 v49, v132, v133, v134
    v_mfma_f32_16x16x32_bf16 v[216:219], v[28:31], v[88:91], v[216:219]
    v_mfma_f32_16x16x32_bf16 v[220:223], v[28:31], v[92:95], v[220:223]
    ds_read_b128 v[28:31], v9 offset:2048
    v_max3_f32 v50, v136, v137, v138
    s_waitcnt lgkmcnt(3)
    v_mfma_f32_16x16x32_bf16 v[224:227], v[16:19], v[64:67], 0
    v_mfma_f32_16x16x32_bf16 v[228:231], v[16:19], v[68:71], 0
    v_max3_f32 v51, v140, v141, v142
    v_mfma_f32_16x16x32_bf16 v[232:235], v[16:19], v[72:75], 0
    s_barrier
    v_mfma_f32_16x16x32_bf16 v[236:239], v[16:19], v[76:79], 0
    v_add_u32 v8, 0x18000, v56
    v_add_u32 v9, 0x18000, v57
    ds_read_b128 v[16:19], v8 offset:0
    s_waitcnt lgkmcnt(3)
    v_mfma_f32_16x16x32_bf16 v[240:243], v[20:23], v[64:67], 0
    ds_read_b128 v[64:67], v2 offset:8192
    v_max3_f32 v48, v48, v131, v144
    v_mfma_f32_16x16x32_bf16 v[244:247], v[20:23], v[68:71], 0
    ds_read_b128 v[68:71], v2 offset:9216
    v_mfma_f32_16x16x32_bf16 v[248:251], v[20:23], v[72:75], 0
    ds_read_b128 v[72:75], v2 offset:10240
    v_max3_f32 v49, v49, v135, v148
    v_mfma_f32_16x16x32_bf16 v[252:255], v[20:23], v[76:79], 0
    ds_read_b128 v[76:79], v2 offset:11264
    ds_read_b128 v[20:23], v8 offset:2048
    s_waitcnt lgkmcnt(7)
    v_mfma_f32_16x16x32_bf16 v[224:227], v[24:27], v[80:83], v[224:227]
    v_max3_f32 v50, v50, v139, v152
    v_mfma_f32_16x16x32_bf16 v[228:231], v[24:27], v[84:87], v[228:231]
    v_mfma_f32_16x16x32_bf16 v[232:235], v[24:27], v[88:91], v[232:235]
    v_max3_f32 v51, v51, v143, v156
    v_mfma_f32_16x16x32_bf16 v[236:239], v[24:27], v[92:95], v[236:239]
    ds_read_b128 v[24:27], v9 offset:0
    s_waitcnt lgkmcnt(7)
    v_mfma_f32_16x16x32_bf16 v[240:243], v[28:31], v[80:83], v[240:243]
    ds_read_b128 v[80:83], v2 offset:12288
    v_max3_f32 v48, v48, v145, v146
    v_mfma_f32_16x16x32_bf16 v[244:247], v[28:31], v[84:87], v[244:247]
    ds_read_b128 v[84:87], v2 offset:13312
    v_mfma_f32_16x16x32_bf16 v[248:251], v[28:31], v[88:91], v[248:251]
    ds_read_b128 v[88:91], v2 offset:14336
    v_mfma_f32_16x16x32_bf16 v[252:255], v[28:31], v[92:95], v[252:255]
    ds_read_b128 v[92:95], v2 offset:15360
    ds_read_b128 v[28:31], v9 offset:2048
    s_waitcnt lgkmcnt(10)
    v_mfma_f32_16x16x32_bf16 v[192:195], v[16:19], v[64:67], v[192:195]
    v_max3_f32 v49, v49, v149, v150
    s_waitcnt lgkmcnt(9)
    v_mfma_f32_16x16x32_bf16 v[196:199], v[16:19], v[68:71], v[196:199]
    v_max3_f32 v50, v50, v153, v154
    s_waitcnt lgkmcnt(8)
    v_mfma_f32_16x16x32_bf16 v[200:203], v[16:19], v[72:75], v[200:203]
    s_barrier
    s_waitcnt lgkmcnt(7)
    v_mfma_f32_16x16x32_bf16 v[204:207], v[16:19], v[76:79], v[204:207]
    v_add_u32 v8, 0x1c000, v56
    v_add_u32 v9, 0x1c000, v57
    ds_read_b128 v[16:19], v8 offset:0
    s_waitcnt lgkmcnt(7)
    v_mfma_f32_16x16x32_bf16 v[208:211], v[20:23], v[64:67], v[208:211]
    v_max3_f32 v51, v51, v157, v158
    v_mfma_f32_16x16x32_bf16 v[212:215], v[20:23], v[68:71], v[212:215]
    v_max3_f32 v48, v48, v147, v160
    v_mfma_f32_16x16x32_bf16 v[216:219], v[20:23], v[72:75], v[216:219]
    v_mfma_f32_16x16x32_bf16 v[220:223], v[20:23], v[76:79], v[220:223]
    ds_read_b128 v[20:23], v8 offset:2048
    v_max3_f32 v49, v49, v151, v164
    s_waitcnt lgkmcnt(6)
    v_mfma_f32_16x16x32_bf16 v[192:195], v[24:27], v[80:83], v[192:195]
    s_waitcnt lgkmcnt(5)
    v_mfma_f32_16x16x32_bf16 v[196:199], v[24:27], v[84:87], v[196:199]
    s_waitcnt lgkmcnt(4)
    v_mfma_f32_16x16x32_bf16 v[200:203], v[24:27], v[88:91], v[200:203]
    v_max3_f32 v50, v50, v155, v168
    s_waitcnt lgkmcnt(3)
    v_mfma_f32_16x16x32_bf16 v[204:207], v[24:27], v[92:95], v[204:207]
    ds_read_b128 v[24:27], v9 offset:0
    s_waitcnt lgkmcnt(3)
    v_mfma_f32_16x16x32_bf16 v[208:211], v[28:31], v[80:83], v[208:211]
    v_max3_f32 v51, v51, v159, v172
    v_mfma_f32_16x16x32_bf16 v[212:215], v[28:31], v[84:87], v[212:215]
    v_mfma_f32_16x16x32_bf16 v[216:219], v[28:31], v[88:91], v[216:219]
    v_max3_f32 v48, v48, v161, v162
    v_mfma_f32_16x16x32_bf16 v[220:223], v[28:31], v[92:95], v[220:223]
    ds_read_b128 v[28:31], v9 offset:2048
    s_waitcnt lgkmcnt(3)
    v_mfma_f32_16x16x32_bf16 v[224:227], v[16:19], v[64:67], v[224:227]
    v_max3_f32 v49, v49, v165, v166
    v_mfma_f32_16x16x32_bf16 v[228:231], v[16:19], v[68:71], v[228:231]
    v_mfma_f32_16x16x32_bf16 v[232:235], v[16:19], v[72:75], v[232:235]
    s_barrier
    v_max3_f32 v50, v50, v169, v170
    v_mfma_f32_16x16x32_bf16 v[236:239], v[16:19], v[76:79], v[236:239]
    v_add_u32 v8, 0x8000, v56
    v_add_u32 v9, 0x8000, v57
    ds_read_b128 v[16:19], v8 offset:0
    s_waitcnt lgkmcnt(3)
    v_mfma_f32_16x16x32_bf16 v[240:243], v[20:23], v[64:67], v[240:243]
    ds_read_b128 v[64:67], v2 offset:16384
    v_mfma_f32_16x16x32_bf16 v[244:247], v[20:23], v[68:71], v[244:247]
    ds_read_b128 v[68:71], v2 offset:17408
    v_max3_f32 v51, v51, v173, v174
    v_mfma_f32_16x16x32_bf16 v[248:251], v[20:23], v[72:75], v[248:251]
    ds_read_b128 v[72:75], v2 offset:18432
    v_mfma_f32_16x16x32_bf16 v[252:255], v[20:23], v[76:79], v[252:255]
    ds_read_b128 v[76:79], v2 offset:19456
    ds_read_b128 v[20:23], v8 offset:2048
    s_waitcnt lgkmcnt(7)
    v_mfma_f32_16x16x32_bf16 v[224:227], v[24:27], v[80:83], v[224:227]
    v_max3_f32 v48, v48, v163, v176
    v_mfma_f32_16x16x32_bf16 v[228:231], v[24:27], v[84:87], v[228:231]
    v_max3_f32 v49, v49, v167, v180
    v_mfma_f32_16x16x32_bf16 v[232:235], v[24:27], v[88:91], v[232:235]
    v_mfma_f32_16x16x32_bf16 v[236:239], v[24:27], v[92:95], v[236:239]
    ds_read_b128 v[24:27], v9 offset:0
    v_max3_f32 v50, v50, v171, v184
    s_waitcnt lgkmcnt(7)
    v_mfma_f32_16x16x32_bf16 v[240:243], v[28:31], v[80:83], v[240:243]
    ds_read_b128 v[80:83], v2 offset:20480
    v_mfma_f32_16x16x32_bf16 v[244:247], v[28:31], v[84:87], v[244:247]
    ds_read_b128 v[84:87], v2 offset:21504
    v_mfma_f32_16x16x32_bf16 v[248:251], v[28:31], v[88:91], v[248:251]
    ds_read_b128 v[88:91], v2 offset:22528
    v_max3_f32 v51, v51, v175, v188
    v_mfma_f32_16x16x32_bf16 v[252:255], v[28:31], v[92:95], v[252:255]
    ds_read_b128 v[92:95], v2 offset:23552
    ds_read_b128 v[28:31], v9 offset:2048
    s_waitcnt lgkmcnt(10)
    v_mfma_f32_16x16x32_bf16 v[192:195], v[16:19], v[64:67], v[192:195]
    v_max3_f32 v48, v48, v177, v178
    s_waitcnt lgkmcnt(9)
    v_mfma_f32_16x16x32_bf16 v[196:199], v[16:19], v[68:71], v[196:199]
    s_waitcnt lgkmcnt(8)
    v_mfma_f32_16x16x32_bf16 v[200:203], v[16:19], v[72:75], v[200:203]
    s_barrier
    v_max3_f32 v49, v49, v181, v182
    s_waitcnt lgkmcnt(7)
    v_mfma_f32_16x16x32_bf16 v[204:207], v[16:19], v[76:79], v[204:207]
    v_add_u32 v8, 0xc000, v56
    v_add_u32 v9, 0xc000, v57
    ds_read_b128 v[16:19], v8 offset:0
    s_waitcnt lgkmcnt(7)
    v_mfma_f32_16x16x32_bf16 v[208:211], v[20:23], v[64:67], v[208:211]
    v_max3_f32 v50, v50, v185, v186
    v_mfma_f32_16x16x32_bf16 v[212:215], v[20:23], v[68:71], v[212:215]
    v_mfma_f32_16x16x32_bf16 v[216:219], v[20:23], v[72:75], v[216:219]
    v_max3_f32 v51, v51, v189, v190
    v_mfma_f32_16x16x32_bf16 v[220:223], v[20:23], v[76:79], v[220:223]
    ds_read_b128 v[20:23], v8 offset:2048
    s_waitcnt lgkmcnt(6)
    v_mfma_f32_16x16x32_bf16 v[192:195], v[24:27], v[80:83], v[192:195]
    s_waitcnt lgkmcnt(5)
    v_mfma_f32_16x16x32_bf16 v[196:199], v[24:27], v[84:87], v[196:199]
    v_max_f32 v48, v48, v179
    s_waitcnt lgkmcnt(4)
    v_mfma_f32_16x16x32_bf16 v[200:203], v[24:27], v[88:91], v[200:203]
    s_waitcnt lgkmcnt(3)
    v_mfma_f32_16x16x32_bf16 v[204:207], v[24:27], v[92:95], v[204:207]
    ds_read_b128 v[24:27], v9 offset:0
    v_max_f32 v49, v49, v183
    s_waitcnt lgkmcnt(3)
    v_mfma_f32_16x16x32_bf16 v[208:211], v[28:31], v[80:83], v[208:211]
    v_mfma_f32_16x16x32_bf16 v[212:215], v[28:31], v[84:87], v[212:215]
    v_max_f32 v50, v50, v187
    v_mfma_f32_16x16x32_bf16 v[216:219], v[28:31], v[88:91], v[216:219]
    v_mfma_f32_16x16x32_bf16 v[220:223], v[28:31], v[92:95], v[220:223]
    ds_read_b128 v[28:31], v9 offset:2048
    v_max_f32 v51, v51, v191
    s_waitcnt lgkmcnt(3)
    v_mfma_f32_16x16x32_bf16 v[224:227], v[16:19], v[64:67], v[224:227]
    v_mfma_f32_16x16x32_bf16 v[228:231], v[16:19], v[68:71], v[228:231]
    v_mfma_f32_16x16x32_bf16 v[232:235], v[16:19], v[72:75], v[232:235]
    s_barrier
    v_mfma_f32_16x16x32_bf16 v[236:239], v[16:19], v[76:79], v[236:239]
    v_add_u32 v8, 0x20000, v56
    v_add_u32 v9, 0x20000, v57
    ds_read_b128 v[16:19], v8 offset:0
    s_waitcnt lgkmcnt(3)
    v_mfma_f32_16x16x32_bf16 v[240:243], v[20:23], v[64:67], v[240:243]
    ds_read_b128 v[64:67], v2 offset:24576
    v_mfma_f32_16x16x32_bf16 v[244:247], v[20:23], v[68:71], v[244:247]
    ds_read_b128 v[68:71], v2 offset:25600
    v_mfma_f32_16x16x32_bf16 v[248:251], v[20:23], v[72:75], v[248:251]
    ds_read_b128 v[72:75], v2 offset:26624
    v_mfma_f32_16x16x32_bf16 v[252:255], v[20:23], v[76:79], v[252:255]
    ds_read_b128 v[76:79], v2 offset:27648
    ds_read_b128 v[20:23], v8 offset:2048
    s_waitcnt lgkmcnt(7)
    v_mfma_f32_16x16x32_bf16 v[224:227], v[24:27], v[80:83], v[224:227]
    v_mfma_f32_16x16x32_bf16 v[228:231], v[24:27], v[84:87], v[228:231]
    v_mfma_f32_16x16x32_bf16 v[232:235], v[24:27], v[88:91], v[232:235]
    v_mfma_f32_16x16x32_bf16 v[236:239], v[24:27], v[92:95], v[236:239]
    ds_read_b128 v[24:27], v9 offset:0
    s_waitcnt lgkmcnt(7)
    v_mfma_f32_16x16x32_bf16 v[240:243], v[28:31], v[80:83], v[240:243]
    ds_read_b128 v[80:83], v2 offset:28672
    v_mfma_f32_16x16x32_bf16 v[244:247], v[28:31], v[84:87], v[244:247]
    ds_read_b128 v[84:87], v2 offset:29696
    v_mfma_f32_16x16x32_bf16 v[248:251], v[28:31], v[88:91], v[248:251]
    ds_read_b128 v[88:91], v2 offset:30720
    v_mfma_f32_16x16x32_bf16 v[252:255], v[28:31], v[92:95], v[252:255]
    ds_read_b128 v[92:95], v2 offset:31744
    ds_read_b128 v[28:31], v9 offset:2048
    s_waitcnt lgkmcnt(10)
    v_mfma_f32_16x16x32_bf16 v[192:195], v[16:19], v[64:67], v[192:195]
    s_waitcnt lgkmcnt(9)
    v_mfma_f32_16x16x32_bf16 v[196:199], v[16:19], v[68:71], v[196:199]
    s_waitcnt lgkmcnt(8)
    v_mfma_f32_16x16x32_bf16 v[200:203], v[16:19], v[72:75], v[200:203]
    s_barrier
    s_waitcnt lgkmcnt(7)
    v_mfma_f32_16x16x32_bf16 v[204:207], v[16:19], v[76:79], v[204:207]
    v_add_u32 v8, 0x24000, v56
    v_add_u32 v9, 0x24000, v57
    ds_read_b128 v[16:19], v8 offset:0
    s_waitcnt lgkmcnt(7)
    v_mfma_f32_16x16x32_bf16 v[208:211], v[20:23], v[64:67], v[208:211]
    v_mfma_f32_16x16x32_bf16 v[212:215], v[20:23], v[68:71], v[212:215]
    v_mfma_f32_16x16x32_bf16 v[216:219], v[20:23], v[72:75], v[216:219]
    v_mfma_f32_16x16x32_bf16 v[220:223], v[20:23], v[76:79], v[220:223]
    ds_read_b128 v[20:23], v8 offset:2048
    s_waitcnt lgkmcnt(6)
    v_mfma_f32_16x16x32_bf16 v[192:195], v[24:27], v[80:83], v[192:195]
    s_waitcnt lgkmcnt(5)
    v_mfma_f32_16x16x32_bf16 v[196:199], v[24:27], v[84:87], v[196:199]
    s_waitcnt lgkmcnt(4)
    v_mfma_f32_16x16x32_bf16 v[200:203], v[24:27], v[88:91], v[200:203]
    s_waitcnt lgkmcnt(3)
    v_mfma_f32_16x16x32_bf16 v[204:207], v[24:27], v[92:95], v[204:207]
    ds_read_b128 v[24:27], v9 offset:0
    s_waitcnt lgkmcnt(3)
    v_mfma_f32_16x16x32_bf16 v[208:211], v[28:31], v[80:83], v[208:211]
    v_mfma_f32_16x16x32_bf16 v[212:215], v[28:31], v[84:87], v[212:215]
    v_mfma_f32_16x16x32_bf16 v[216:219], v[28:31], v[88:91], v[216:219]
    v_mfma_f32_16x16x32_bf16 v[220:223], v[28:31], v[92:95], v[220:223]
    ds_read_b128 v[28:31], v9 offset:2048
    s_waitcnt lgkmcnt(3)
    v_mfma_f32_16x16x32_bf16 v[224:227], v[16:19], v[64:67], v[224:227]
    v_mfma_f32_16x16x32_bf16 v[228:231], v[16:19], v[68:71], v[228:231]
    v_mfma_f32_16x16x32_bf16 v[232:235], v[16:19], v[72:75], v[232:235]
    s_waitcnt lgkmcnt(0)
    s_barrier
    v_mfma_f32_16x16x32_bf16 v[236:239], v[16:19], v[76:79], v[236:239]
    v_mfma_f32_16x16x32_bf16 v[240:243], v[20:23], v[64:67], v[240:243]
    s_nop 7
    v_max3_f32 v48, v48, v192, v193
    v_mfma_f32_16x16x32_bf16 v[244:247], v[20:23], v[68:71], v[244:247]
    v_max3_f32 v49, v49, v196, v197
    v_mfma_f32_16x16x32_bf16 v[248:251], v[20:23], v[72:75], v[248:251]
    v_max3_f32 v50, v50, v200, v201
    v_max3_f32 v51, v51, v204, v205
    v_mfma_f32_16x16x32_bf16 v[252:255], v[20:23], v[76:79], v[252:255]
    v_max3_f32 v48, v48, v194, v195
    v_mfma_f32_16x16x32_bf16 v[224:227], v[24:27], v[80:83], v[224:227]
    v_max3_f32 v49, v49, v198, v199
    v_mfma_f32_16x16x32_bf16 v[228:231], v[24:27], v[84:87], v[228:231]
    v_max3_f32 v50, v50, v202, v203
    v_max3_f32 v51, v51, v206, v207
    v_mfma_f32_16x16x32_bf16 v[232:235], v[24:27], v[88:91], v[232:235]
    v_max3_f32 v48, v48, v208, v209
    v_mfma_f32_16x16x32_bf16 v[236:239], v[24:27], v[92:95], v[236:239]
    v_max3_f32 v49, v49, v212, v213
    v_max3_f32 v50, v50, v216, v217
    v_mfma_f32_16x16x32_bf16 v[240:243], v[28:31], v[80:83], v[240:243]
    v_max3_f32 v51, v51, v220, v221
    v_mfma_f32_16x16x32_bf16 v[244:247], v[28:31], v[84:87], v[244:247]
    v_max3_f32 v48, v48, v210, v211
    v_mfma_f32_16x16x32_bf16 v[248:251], v[28:31], v[88:91], v[248:251]
    v_max3_f32 v49, v49, v214, v215
    v_max3_f32 v50, v50, v218, v219
    v_mfma_f32_16x16x32_bf16 v[252:255], v[28:31], v[92:95], v[252:255]
    v_max3_f32 v51, v51, v222, v223
    s_nop 7
    s_nop 1
    v_max3_f32 v48, v48, v224, v225
    v_max3_f32 v49, v49, v228, v229
    v_max3_f32 v50, v50, v232, v233
    v_max3_f32 v51, v51, v236, v237
    v_max3_f32 v48, v48, v226, v227
    v_max3_f32 v49, v49, v230, v231
    v_max3_f32 v50, v50, v234, v235
    v_max3_f32 v51, v51, v238, v239
    v_max3_f32 v48, v48, v240, v241
    v_max3_f32 v49, v49, v244, v245
    v_max3_f32 v50, v50, v248, v249
    v_max3_f32 v51, v51, v252, v253
    v_max3_f32 v48, v48, v242, v243
    v_max3_f32 v49, v49, v246, v247
    v_max3_f32 v50, v50, v250, v251
    v_max3_f32 v51, v51, v254, v255
    v_mov_b32 v32, v48
    v_mov_b32 v33, v49
    v_mov_b32 v34, v50
    v_mov_b32 v35, v51
    s_nop 1
    v_permlane32_swap_b32 v48, v32
    v_permlane32_swap_b32 v49, v33
    v_permlane32_swap_b32 v50, v34
    v_permlane32_swap_b32 v51, v35
    s_nop 0
    v_max_f32 v48, v48, v32
    v_max_f32 v49, v49, v33
    v_max_f32 v50, v50, v34
    v_max_f32 v51, v51, v35
    v_mov_b32 v32, v48
    v_mov_b32 v33, v49
    v_mov_b32 v34, v50
    v_mov_b32 v35, v51
    s_nop 1
    v_permlane16_swap_b32 v48, v32
    v_permlane16_swap_b32 v49, v33
    v_permlane16_swap_b32 v50, v34
    v_permlane16_swap_b32 v51, v35
    s_nop 0
    v_max_f32 v48, v48, v32
    v_max_f32 v49, v49, v33
    v_max_f32 v50, v50, v34
    v_max_f32 v51, v51, v35
    s_mov_b64 exec, 0xffff
    ds_write_b32 v58, v48 offset:0
    ds_write_b32 v58, v49 offset:256
    ds_write_b32 v58, v50 offset:512
    ds_write_b32 v58, v51 offset:768
    s_mov_b64 exec, -1
    s_waitcnt lgkmcnt(0)
    s_barrier
    ds_read_b128 v[16:19], v59 offset:0
    ds_read_b128 v[20:23], v59 offset:256
    ds_read_b128 v[24:27], v59 offset:512
    ds_read_b128 v[28:31], v59 offset:768
    s_waitcnt lgkmcnt(0)
    v_max3_f32 v48, v16, v17, v18
    v_max3_f32 v49, v20, v21, v22
    v_max3_f32 v50, v24, v25, v26
    v_max3_f32 v51, v28, v29, v30
    v_max_f32 v48, v48, v19
    v_max_f32 v49, v49, v23
    v_max_f32 v50, v50, v27
    v_max_f32 v51, v51, v31
    v_mul_f32 v48, s48, v48
    v_mul_f32 v49, s48, v49
    v_mul_f32 v50, s48, v50
    v_mul_f32 v51, s48, v51
    v_fma_f32 v128, v128, s48, -v48
    v_fma_f32 v129, v129, s48, -v48
    v_fma_f32 v130, v130, s48, -v48
    v_exp_f32 v128, v128
    v_fma_f32 v131, v131, s48, -v48
    v_exp_f32 v129, v129
    v_fma_f32 v144, v144, s48, -v48
    v_exp_f32 v130, v130
    v_fma_f32 v145, v145, s48, -v48
    v_exp_f32 v131, v131
    v_cvt_pk_bf16_f32 v64, v128, v129
    v_fma_f32 v146, v146, s48, -v48
    v_exp_f32 v144, v144
    v_fma_f32 v147, v147, s48, -v48
    v_exp_f32 v145, v145
    v_cvt_pk_bf16_f32 v65, v130, v131
    v_fma_f32 v132, v132, s48, -v49
    v_exp_f32 v146, v146
    v_fma_f32 v133, v133, s48, -v49
    v_exp_f32 v147, v147
    v_cvt_pk_bf16_f32 v66, v144, v145
    v_fma_f32 v134, v134, s48, -v49
    v_exp_f32 v132, v132
    v_fma_f32 v135, v135, s48, -v49
    v_exp_f32 v133, v133
    v_cvt_pk_bf16_f32 v67, v146, v147
    v_fma_f32 v148, v148, s48, -v49
    v_exp_f32 v134, v134
    v_fma_f32 v149, v149, s48, -v49
    v_exp_f32 v135, v135
    v_cvt_pk_bf16_f32 v68, v132, v133
    v_fma_f32 v150, v150, s48, -v49
    v_exp_f32 v148, v148
    v_fma_f32 v151, v151, s48, -v49
    v_exp_f32 v149, v149
    v_cvt_pk_bf16_f32 v69, v134, v135
    v_fma_f32 v136, v136, s48, -v50
    v_exp_f32 v150, v150
    v_fma_f32 v137, v137, s48, -v50
    v_exp_f32 v151, v151
    v_cvt_pk_bf16_f32 v70, v148, v149
    v_fma_f32 v138, v138, s48, -v50
    v_exp_f32 v136, v136
    v_fma_f32 v139, v139, s48, -v50
    v_exp_f32 v137, v137
    v_cvt_pk_bf16_f32 v71, v150, v151
    v_fma_f32 v152, v152, s48, -v50
    v_exp_f32 v138, v138
    v_fma_f32 v153, v153, s48, -v50
    v_exp_f32 v139, v139
    v_cvt_pk_bf16_f32 v72, v136, v137
    v_fma_f32 v154, v154, s48, -v50
    v_exp_f32 v152, v152
    v_fma_f32 v155, v155, s48, -v50
    v_exp_f32 v153, v153
    v_cvt_pk_bf16_f32 v73, v138, v139
    v_fma_f32 v140, v140, s48, -v51
    v_exp_f32 v154, v154
    v_fma_f32 v141, v141, s48, -v51
    v_exp_f32 v155, v155
    v_cvt_pk_bf16_f32 v74, v152, v153
    v_fma_f32 v142, v142, s48, -v51
    v_exp_f32 v140, v140
    v_fma_f32 v143, v143, s48, -v51
    v_exp_f32 v141, v141
    v_cvt_pk_bf16_f32 v75, v154, v155
    v_fma_f32 v156, v156, s48, -v51
    v_exp_f32 v142, v142
    v_fma_f32 v157, v157, s48, -v51
    v_exp_f32 v143, v143
    v_cvt_pk_bf16_f32 v76, v140, v141
    v_fma_f32 v158, v158, s48, -v51
    v_exp_f32 v156, v156
    v_fma_f32 v159, v159, s48, -v51
    v_exp_f32 v157, v157
    v_cvt_pk_bf16_f32 v77, v142, v143
    v_exp_f32 v158, v158
    v_exp_f32 v159, v159
    v_cvt_pk_bf16_f32 v78, v156, v157
    v_cvt_pk_bf16_f32 v79, v158, v159
    ds_write_b128 v60, v[64:67] offset:0
    ds_write_b128 v60, v[68:71] offset:1024
    ds_write_b128 v60, v[72:75] offset:2048
    ds_write_b128 v60, v[76:79] offset:3072
    v_fma_f32 v160, v160, s48, -v48
    v_fma_f32 v161, v161, s48, -v48
    v_fma_f32 v162, v162, s48, -v48
    v_exp_f32 v160, v160
    v_fma_f32 v163, v163, s48, -v48
    v_exp_f32 v161, v161
    v_fma_f32 v176, v176, s48, -v48
    v_exp_f32 v162, v162
    v_fma_f32 v177, v177, s48, -v48
    v_exp_f32 v163, v163
    v_cvt_pk_bf16_f32 v80, v160, v161
    v_fma_f32 v178, v178, s48, -v48
    v_exp_f32 v176, v176
    v_fma_f32 v179, v179, s48, -v48
    v_exp_f32 v177, v177
    v_cvt_pk_bf16_f32 v81, v162, v163
    v_fma_f32 v164, v164, s48, -v49
    v_exp_f32 v178, v178
    v_fma_f32 v165, v165, s48, -v49
    v_exp_f32 v179, v179
    v_cvt_pk_bf16_f32 v82, v176, v177
    v_fma_f32 v166, v166, s48, -v49
    v_exp_f32 v164, v164
    v_fma_f32 v167, v167, s48, -v49
    v_exp_f32 v165, v165
    v_cvt_pk_bf16_f32 v83, v178, v179
    v_fma_f32 v180, v180, s48, -v49
    v_exp_f32 v166, v166
    v_fma_f32 v181, v181, s48, -v49
    v_exp_f32 v167, v167
    v_cvt_pk_bf16_f32 v84, v164, v165
    v_fma_f32 v182, v182, s48, -v49
    v_exp_f32 v180, v180
    v_fma_f32 v183, v183, s48, -v49
    v_exp_f32 v181, v181
    v_cvt_pk_bf16_f32 v85, v166, v167
    v_fma_f32 v168, v168, s48, -v50
    v_exp_f32 v182, v182
    v_fma_f32 v169, v169, s48, -v50
    v_exp_f32 v183, v183
    v_cvt_pk_bf16_f32 v86, v180, v181
    v_fma_f32 v170, v170, s48, -v50
    v_exp_f32 v168, v168
    v_fma_f32 v171, v171, s48, -v50
    v_exp_f32 v169, v169
    v_cvt_pk_bf16_f32 v87, v182, v183
    v_fma_f32 v184, v184, s48, -v50
    v_exp_f32 v170, v170
    v_fma_f32 v185, v185, s48, -v50
    v_exp_f32 v171, v171
    v_cvt_pk_bf16_f32 v88, v168, v169
    v_fma_f32 v186, v186, s48, -v50
    v_exp_f32 v184, v184
    v_fma_f32 v187, v187, s48, -v50
    v_exp_f32 v185, v185
    v_cvt_pk_bf16_f32 v89, v170, v171
    v_fma_f32 v172, v172, s48, -v51
    v_exp_f32 v186, v186
    v_fma_f32 v173, v173, s48, -v51
    v_exp_f32 v187, v187
    v_cvt_pk_bf16_f32 v90, v184, v185
    v_fma_f32 v174, v174, s48, -v51
    v_exp_f32 v172, v172
    v_fma_f32 v175, v175, s48, -v51
    v_exp_f32 v173, v173
    v_cvt_pk_bf16_f32 v91, v186, v187
    v_fma_f32 v188, v188, s48, -v51
    v_exp_f32 v174, v174
    v_fma_f32 v189, v189, s48, -v51
    v_exp_f32 v175, v175
    v_cvt_pk_bf16_f32 v92, v172, v173
    v_fma_f32 v190, v190, s48, -v51
    v_exp_f32 v188, v188
    v_fma_f32 v191, v191, s48, -v51
    v_exp_f32 v189, v189
    v_cvt_pk_bf16_f32 v93, v174, v175
    v_exp_f32 v190, v190
    v_exp_f32 v191, v191
    v_cvt_pk_bf16_f32 v94, v188, v189
    v_cvt_pk_bf16_f32 v95, v190, v191
    ds_write_b128 v60, v[80:83] offset:16384
    ds_write_b128 v60, v[84:87] offset:17408
    ds_write_b128 v60, v[88:91] offset:18432
    ds_write_b128 v60, v[92:95] offset:19456
    s_waitcnt lgkmcnt(0)
    s_barrier
    v_add_u32 v8, 0x10000, v4
    v_xor_b32 v9, 32, v8
    v_xor_b32 v10, 64, v8
    v_xor_b32 v11, 96, v8
    ds_read_b64_tr_b16 v[16:17], v8 offset:0
    ds_read_b64_tr_b16 v[18:19], v8 offset:2048
    ds_read_b128 v[32:35], v2 offset:0
    ds_read_b128 v[36:39], v2 offset:1024
    ds_read_b64_tr_b16 v[20:21], v9 offset:0
    ds_read_b64_tr_b16 v[22:23], v9 offset:2048
    ds_read_b64_tr_b16 v[24:25], v10 offset:0
    ds_read_b64_tr_b16 v[26:27], v10 offset:2048
    ds_read_b64_tr_b16 v[28:29], v11 offset:0
    ds_read_b64_tr_b16 v[30:31], v11 offset:2048
    ds_read_b128 v[40:43], v2 offset:2048
    ds_read_b128 v[44:47], v2 offset:3072
    s_waitcnt lgkmcnt(9)
    v_mfma_f32_16x16x32_bf16 v[64:67], v[16:19], v[32:35], 0
    v_mov_b32 v52, v128
    v_mov_b32 v53, v132
    s_waitcnt lgkmcnt(8)
    v_mfma_f32_16x16x32_bf16 v[68:71], v[16:19], v[36:39], 0
    v_mov_b32 v54, v136
    v_mov_b32 v55, v140
    s_waitcnt lgkmcnt(6)
    v_mfma_f32_16x16x32_bf16 v[80:83], v[20:23], v[32:35], 0
    v_add_f32 v52, v52, v129
    v_add_f32 v53, v53, v133
    v_mfma_f32_16x16x32_bf16 v[84:87], v[20:23], v[36:39], 0
    v_add_f32 v54, v54, v137
    v_add_f32 v55, v55, v141
    s_waitcnt lgkmcnt(4)
    v_mfma_f32_16x16x32_bf16 v[96:99], v[24:27], v[32:35], 0
    v_add_f32 v52, v52, v130
    v_add_f32 v53, v53, v134
    v_mfma_f32_16x16x32_bf16 v[100:103], v[24:27], v[36:39], 0
    s_barrier
    v_add_f32 v54, v54, v138
    v_add_f32 v55, v55, v142
    s_waitcnt lgkmcnt(2)
    v_mfma_f32_16x16x32_bf16 v[112:115], v[28:31], v[32:35], 0
    ds_read_b128 v[32:35], v2 offset:4096
    v_add_f32 v52, v52, v131
    v_add_f32 v53, v53, v135
    v_mfma_f32_16x16x32_bf16 v[116:119], v[28:31], v[36:39], 0
    ds_read_b128 v[36:39], v2 offset:5120
    v_add_f32 v54, v54, v139
    v_add_f32 v55, v55, v143
    s_waitcnt lgkmcnt(3)
    v_mfma_f32_16x16x32_bf16 v[72:75], v[16:19], v[40:43], 0
    v_add_f32 v52, v52, v144
    v_add_f32 v53, v53, v148
    s_waitcnt lgkmcnt(2)
    v_mfma_f32_16x16x32_bf16 v[76:79], v[16:19], v[44:47], 0
    v_add_u32 v8, 0x14000, v4
    v_xor_b32 v9, 32, v8
    v_xor_b32 v10, 64, v8
    v_xor_b32 v11, 96, v8
    ds_read_b64_tr_b16 v[16:17], v8 offset:0
    ds_read_b64_tr_b16 v[18:19], v8 offset:2048
    v_add_f32 v54, v54, v152
    v_add_f32 v55, v55, v156
    v_mfma_f32_16x16x32_bf16 v[88:91], v[20:23], v[40:43], 0
    v_add_f32 v52, v52, v145
    v_add_f32 v53, v53, v149
    v_add_f32 v54, v54, v153
    v_mfma_f32_16x16x32_bf16 v[92:95], v[20:23], v[44:47], 0
    ds_read_b64_tr_b16 v[20:21], v9 offset:0
    ds_read_b64_tr_b16 v[22:23], v9 offset:2048
    v_add_f32 v55, v55, v157
    v_add_f32 v52, v52, v146
    v_mfma_f32_16x16x32_bf16 v[104:107], v[24:27], v[40:43], 0
    v_add_f32 v53, v53, v150
    v_add_f32 v54, v54, v154
    v_mfma_f32_16x16x32_bf16 v[108:111], v[24:27], v[44:47], 0
    ds_read_b64_tr_b16 v[24:25], v10 offset:0
    ds_read_b64_tr_b16 v[26:27], v10 offset:2048
    v_add_f32 v55, v55, v158
    v_add_f32 v52, v52, v147
    v_mfma_f32_16x16x32_bf16 v[120:123], v[28:31], v[40:43], 0
    ds_read_b128 v[40:43], v2 offset:6144
    v_add_f32 v53, v53, v151
    v_add_f32 v54, v54, v155
    v_mfma_f32_16x16x32_bf16 v[124:127], v[28:31], v[44:47], 0
    ds_read_b64_tr_b16 v[28:29], v11 offset:0
    ds_read_b64_tr_b16 v[30:31], v11 offset:2048
    v_add_f32 v55, v55, v159
    v_fma_f32 v192, v192, s48, -v48
    v_fma_f32 v193, v193, s48, -v48
    s_waitcnt lgkmcnt(7)
    v_mfma_f32_16x16x32_bf16 v[64:67], v[16:19], v[32:35], v[64:67]
    ds_read_b128 v[44:47], v2 offset:7168
    v_fma_f32 v194, v194, s48, -v48
    v_exp_f32 v192, v192
    v_mfma_f32_16x16x32_bf16 v[68:71], v[16:19], v[36:39], v[68:71]
    v_fma_f32 v195, v195, s48, -v48
    v_exp_f32 v193, v193
    s_waitcnt lgkmcnt(6)
    v_mfma_f32_16x16x32_bf16 v[80:83], v[20:23], v[32:35], v[80:83]
    v_fma_f32 v208, v208, s48, -v48
    v_mfma_f32_16x16x32_bf16 v[84:87], v[20:23], v[36:39], v[84:87]
    v_exp_f32 v194, v194
    s_waitcnt lgkmcnt(4)
    v_mfma_f32_16x16x32_bf16 v[96:99], v[24:27], v[32:35], v[96:99]
    v_fma_f32 v209, v209, s48, -v48
    v_exp_f32 v195, v195
    v_mfma_f32_16x16x32_bf16 v[100:103], v[24:27], v[36:39], v[100:103]
    s_barrier
    v_cvt_pk_bf16_f32 v128, v192, v193
    v_fma_f32 v210, v210, s48, -v48
    s_waitcnt lgkmcnt(1)
    v_mfma_f32_16x16x32_bf16 v[112:115], v[28:31], v[32:35], v[112:115]
    ds_read_b128 v[32:35], v2 offset:8192
    v_exp_f32 v208, v208
    v_mfma_f32_16x16x32_bf16 v[116:119], v[28:31], v[36:39], v[116:119]
    ds_read_b128 v[36:39], v2 offset:9216
    v_fma_f32 v211, v211, s48, -v48
    v_mfma_f32_16x16x32_bf16 v[72:75], v[16:19], v[40:43], v[72:75]
    v_exp_f32 v209, v209
    s_waitcnt lgkmcnt(2)
    v_mfma_f32_16x16x32_bf16 v[76:79], v[16:19], v[44:47], v[76:79]
    v_add_u32 v8, 0x18000, v4
    v_xor_b32 v9, 32, v8
    v_xor_b32 v10, 64, v8
    v_xor_b32 v11, 96, v8
    ds_read_b64_tr_b16 v[16:17], v8 offset:0
    ds_read_b64_tr_b16 v[18:19], v8 offset:2048
    v_cvt_pk_bf16_f32 v129, v194, v195
    v_fma_f32 v196, v196, s48, -v49
    v_exp_f32 v210, v210
    v_mfma_f32_16x16x32_bf16 v[88:91], v[20:23], v[40:43], v[88:91]
    v_fma_f32 v197, v197, s48, -v49
    v_exp_f32 v211, v211
    v_mfma_f32_16x16x32_bf16 v[92:95], v[20:23], v[44:47], v[92:95]
    ds_read_b64_tr_b16 v[20:21], v9 offset:0
    ds_read_b64_tr_b16 v[22:23], v9 offset:2048
    v_mfma_f32_16x16x32_bf16 v[104:107], v[24:27], v[40:43], v[104:107]
    v_cvt_pk_bf16_f32 v130, v208, v209
    v_fma_f32 v198, v198, s48, -v49
    v_mfma_f32_16x16x32_bf16 v[108:111], v[24:27], v[44:47], v[108:111]
    ds_read_b64_tr_b16 v[24:25], v10 offset:0
    ds_read_b64_tr_b16 v[26:27], v10 offset:2048
    v_exp_f32 v196, v196
    v_mfma_f32_16x16x32_bf16 v[120:123], v[28:31], v[40:43], v[120:123]
    ds_read_b128 v[40:43], v2 offset:10240
    v_fma_f32 v199, v199, s48, -v49
    v_exp_f32 v197, v197
    v_mfma_f32_16x16x32_bf16 v[124:127], v[28:31], v[44:47], v[124:127]
    ds_read_b64_tr_b16 v[28:29], v11 offset:0
    ds_read_b64_tr_b16 v[30:31], v11 offset:2048
    v_cvt_pk_bf16_f32 v131, v210, v211
    v_fma_f32 v212, v212, s48, -v49
    s_waitcnt lgkmcnt(7)
    v_mfma_f32_16x16x32_bf16 v[64:67], v[16:19], v[32:35], v[64:67]
    ds_read_b128 v[44:47], v2 offset:11264
    v_exp_f32 v198, v198
    v_mfma_f32_16x16x32_bf16 v[68:71], v[16:19], v[36:39], v[68:71]
    v_fma_f32 v213, v213, s48, -v49
    v_exp_f32 v199, v199
    s_waitcnt lgkmcnt(6)
    v_mfma_f32_16x16x32_bf16 v[80:83], v[20:23], v[32:35], v[80:83]
    v_cvt_pk_bf16_f32 v132, v196, v197
    v_fma_f32 v214, v214, s48, -v49
    v_mfma_f32_16x16x32_bf16 v[84:87], v[20:23], v[36:39], v[84:87]
    v_exp_f32 v212, v212
    s_waitcnt lgkmcnt(4)
    v_mfma_f32_16x16x32_bf16 v[96:99], v[24:27], v[32:35], v[96:99]
    v_fma_f32 v215, v215, s48, -v49
    v_exp_f32 v213, v213
    v_mfma_f32_16x16x32_bf16 v[100:103], v[24:27], v[36:39], v[100:103]
    s_barrier
    v_cvt_pk_bf16_f32 v133, v198, v199
    v_fma_f32 v200, v200, s48, -v50
    s_waitcnt lgkmcnt(1)
    v_mfma_f32_16x16x32_bf16 v[112:115], v[28:31], v[32:35], v[112:115]
    ds_read_b128 v[32:35], v2 offset:12288
    v_exp_f32 v214, v214
    v_mfma_f32_16x16x32_bf16 v[116:119], v[28:31], v[36:39], v[116:119]
    ds_read_b128 v[36:39], v2 offset:13312
    v_fma_f32 v201, v201, s48, -v50
    v_mfma_f32_16x16x32_bf16 v[72:75], v[16:19], v[40:43], v[72:75]
    v_exp_f32 v215, v215
    v_cvt_pk_bf16_f32 v134, v212, v213
    s_waitcnt lgkmcnt(2)
    v_mfma_f32_16x16x32_bf16 v[76:79], v[16:19], v[44:47], v[76:79]
    v_add_u32 v8, 0x1c000, v4
    v_xor_b32 v9, 32, v8
    v_xor_b32 v10, 64, v8
    v_xor_b32 v11, 96, v8
    ds_read_b64_tr_b16 v[16:17], v8 offset:0
    ds_read_b64_tr_b16 v[18:19], v8 offset:2048
    v_fma_f32 v202, v202, s48, -v50
    v_exp_f32 v200, v200
    v_mfma_f32_16x16x32_bf16 v[88:91], v[20:23], v[40:43], v[88:91]
    v_fma_f32 v203, v203, s48, -v50
    v_exp_f32 v201, v201
    v_mfma_f32_16x16x32_bf16 v[92:95], v[20:23], v[44:47], v[92:95]
    ds_read_b64_tr_b16 v[20:21], v9 offset:0
    ds_read_b64_tr_b16 v[22:23], v9 offset:2048
    v_mfma_f32_16x16x32_bf16 v[104:107], v[24:27], v[40:43], v[104:107]
    v_cvt_pk_bf16_f32 v135, v214, v215
    v_fma_f32 v216, v216, s48, -v50
    v_mfma_f32_16x16x32_bf16 v[108:111], v[24:27], v[44:47], v[108:111]
    ds_read_b64_tr_b16 v[24:25], v10 offset:0
    ds_read_b64_tr_b16 v[26:27], v10 offset:2048
    v_exp_f32 v202, v202
    v_fma_f32 v217, v217, s48, -v50
    v_mfma_f32_16x16x32_bf16 v[120:123], v[28:31], v[40:43], v[120:123]
    ds_read_b128 v[40:43], v2 offset:14336
    v_exp_f32 v203, v203
    v_mfma_f32_16x16x32_bf16 v[124:127], v[28:31], v[44:47], v[124:127]
    ds_read_b64_tr_b16 v[28:29], v11 offset:0
    ds_read_b64_tr_b16 v[30:31], v11 offset:2048
    v_cvt_pk_bf16_f32 v136, v200, v201
    v_fma_f32 v218, v218, s48, -v50
    s_waitcnt lgkmcnt(7)
    v_mfma_f32_16x16x32_bf16 v[64:67], v[16:19], v[32:35], v[64:67]
    ds_read_b128 v[44:47], v2 offset:15360
    v_exp_f32 v216, v216
    v_mfma_f32_16x16x32_bf16 v[68:71], v[16:19], v[36:39], v[68:71]
    v_fma_f32 v219, v219, s48, -v50
    v_exp_f32 v217, v217
    s_waitcnt lgkmcnt(6)
    v_mfma_f32_16x16x32_bf16 v[80:83], v[20:23], v[32:35], v[80:83]
    v_cvt_pk_bf16_f32 v137, v202, v203
    v_fma_f32 v204, v204, s48, -v51
    v_mfma_f32_16x16x32_bf16 v[84:87], v[20:23], v[36:39], v[84:87]
    v_exp_f32 v218, v218
    s_waitcnt lgkmcnt(4)
    v_mfma_f32_16x16x32_bf16 v[96:99], v[24:27], v[32:35], v[96:99]
    v_fma_f32 v205, v205, s48, -v51
    v_exp_f32 v219, v219
    v_mfma_f32_16x16x32_bf16 v[100:103], v[24:27], v[36:39], v[100:103]
    s_barrier
    v_cvt_pk_bf16_f32 v138, v216, v217
    v_fma_f32 v206, v206, s48, -v51
    s_waitcnt lgkmcnt(1)
    v_mfma_f32_16x16x32_bf16 v[112:115], v[28:31], v[32:35], v[112:115]
    ds_read_b128 v[32:35], v2 offset:16384
    v_exp_f32 v204, v204
    v_mfma_f32_16x16x32_bf16 v[116:119], v[28:31], v[36:39], v[116:119]
    ds_read_b128 v[36:39], v2 offset:17408
    v_fma_f32 v207, v207, s48, -v51
    v_mfma_f32_16x16x32_bf16 v[72:75], v[16:19], v[40:43], v[72:75]
    v_exp_f32 v205, v205
    v_cvt_pk_bf16_f32 v139, v218, v219
    s_waitcnt lgkmcnt(2)
    v_mfma_f32_16x16x32_bf16 v[76:79], v[16:19], v[44:47], v[76:79]
    v_add_u32 v8, 0x8000, v4
    v_xor_b32 v9, 32, v8
    v_xor_b32 v10, 64, v8
    v_xor_b32 v11, 96, v8
    ds_read_b64_tr_b16 v[16:17], v8 offset:0
    ds_read_b64_tr_b16 v[18:19], v8 offset:2048
    v_fma_f32 v220, v220, s48, -v51
    v_exp_f32 v206, v206
    v_mfma_f32_16x16x32_bf16 v[88:91], v[20:23], v[40:43], v[88:91]
    v_fma_f32 v221, v221, s48, -v51
    v_exp_f32 v207, v207
    v_mfma_f32_16x16x32_bf16 v[92:95], v[20:23], v[44:47], v[92:95]
    ds_read_b64_tr_b16 v[20:21], v9 offset:0
    ds_read_b64_tr_b16 v[22:23], v9 offset:2048
    v_mfma_f32_16x16x32_bf16 v[104:107], v[24:27], v[40:43], v[104:107]
    v_cvt_pk_bf16_f32 v140, v204, v205
    v_fma_f32 v222, v222, s48, -v51
    v_mfma_f32_16x16x32_bf16 v[108:111], v[24:27], v[44:47], v[108:111]
    ds_read_b64_tr_b16 v[24:25], v10 offset:0
    ds_read_b64_tr_b16 v[26:27], v10 offset:2048
    v_exp_f32 v220, v220
    v_fma_f32 v223, v223, s48, -v51
    v_mfma_f32_16x16x32_bf16 v[120:123], v[28:31], v[40:43], v[120:123]
    ds_read_b128 v[40:43], v2 offset:18432
    v_exp_f32 v221, v221
    v_mfma_f32_16x16x32_bf16 v[124:127], v[28:31], v[44:47], v[124:127]
    ds_read_b64_tr_b16 v[28:29], v11 offset:0
    ds_read_b64_tr_b16 v[30:31], v11 offset:2048
    v_cvt_pk_bf16_f32 v141, v206, v207
    v_exp_f32 v222, v222
    s_waitcnt lgkmcnt(7)
    v_mfma_f32_16x16x32_bf16 v[64:67], v[16:19], v[32:35], v[64:67]
    ds_read_b128 v[44:47], v2 offset:19456
    v_exp_f32 v223, v223
    v_mfma_f32_16x16x32_bf16 v[68:71], v[16:19], v[36:39], v[68:71]
    v_cvt_pk_bf16_f32 v142, v220, v221
    v_cvt_pk_bf16_f32 v143, v222, v223
    s_waitcnt lgkmcnt(6)
    v_mfma_f32_16x16x32_bf16 v[80:83], v[20:23], v[32:35], v[80:83]
    v_fma_f32 v224, v224, s48, -v48
    v_fma_f32 v225, v225, s48, -v48
    v_mfma_f32_16x16x32_bf16 v[84:87], v[20:23], v[36:39], v[84:87]
    v_fma_f32 v226, v226, s48, -v48
    v_exp_f32 v224, v224
    s_waitcnt lgkmcnt(4)
    v_mfma_f32_16x16x32_bf16 v[96:99], v[24:27], v[32:35], v[96:99]
    v_fma_f32 v227, v227, s48, -v48
    v_exp_f32 v225, v225
    v_mfma_f32_16x16x32_bf16 v[100:103], v[24:27], v[36:39], v[100:103]
    s_barrier
    v_fma_f32 v240, v240, s48, -v48
    s_waitcnt lgkmcnt(1)
    v_mfma_f32_16x16x32_bf16 v[112:115], v[28:31], v[32:35], v[112:115]
    ds_read_b128 v[32:35], v2 offset:20480
    v_exp_f32 v226, v226
    v_mfma_f32_16x16x32_bf16 v[116:119], v[28:31], v[36:39], v[116:119]
    ds_read_b128 v[36:39], v2 offset:21504
    v_fma_f32 v241, v241, s48, -v48
    v_exp_f32 v227, v227
    v_mfma_f32_16x16x32_bf16 v[72:75], v[16:19], v[40:43], v[72:75]
    v_cvt_pk_bf16_f32 v144, v224, v225
    v_fma_f32 v242, v242, s48, -v48
    s_waitcnt lgkmcnt(2)
    v_mfma_f32_16x16x32_bf16 v[76:79], v[16:19], v[44:47], v[76:79]
    v_add_u32 v8, 0xc000, v4
    v_xor_b32 v9, 32, v8
    v_xor_b32 v10, 64, v8
    v_xor_b32 v11, 96, v8
    ds_read_b64_tr_b16 v[16:17], v8 offset:0
    ds_read_b64_tr_b16 v[18:19], v8 offset:2048
    v_exp_f32 v240, v240
    v_mfma_f32_16x16x32_bf16 v[88:91], v[20:23], v[40:43], v[88:91]
    v_fma_f32 v243, v243, s48, -v48
    v_exp_f32 v241, v241
    v_mfma_f32_16x16x32_bf16 v[92:95], v[20:23], v[44:47], v[92:95]
    ds_read_b64_tr_b16 v[20:21], v9 offset:0
    ds_read_b64_tr_b16 v[22:23], v9 offset:2048
    v_mfma_f32_16x16x32_bf16 v[104:107], v[24:27], v[40:43], v[104:107]
    v_cvt_pk_bf16_f32 v145, v226, v227
    v_fma_f32 v228, v228, s48, -v49
    v_exp_f32 v242, v242
    v_mfma_f32_16x16x32_bf16 v[108:111], v[24:27], v[44:47], v[108:111]
    ds_read_b64_tr_b16 v[24:25], v10 offset:0
    ds_read_b64_tr_b16 v[26:27], v10 offset:2048
    v_fma_f32 v229, v229, s48, -v49
    v_mfma_f32_16x16x32_bf16 v[120:123], v[28:31], v[40:43], v[120:123]
    ds_read_b128 v[40:43], v2 offset:22528
    v_exp_f32 v243, v243
    v_mfma_f32_16x16x32_bf16 v[124:127], v[28:31], v[44:47], v[124:127]
    ds_read_b64_tr_b16 v[28:29], v11 offset:0
    ds_read_b64_tr_b16 v[30:31], v11 offset:2048
    v_cvt_pk_bf16_f32 v146, v240, v241
    v_fma_f32 v230, v230, s48, -v49
    s_waitcnt lgkmcnt(7)
    v_mfma_f32_16x16x32_bf16 v[64:67], v[16:19], v[32:35], v[64:67]
    ds_read_b128 v[44:47], v2 offset:23552
    v_exp_f32 v228, v228
    v_mfma_f32_16x16x32_bf16 v[68:71], v[16:19], v[36:39], v[68:71]
    v_fma_f32 v231, v231, s48, -v49
    v_exp_f32 v229, v229
    s_waitcnt lgkmcnt(6)
    v_mfma_f32_16x16x32_bf16 v[80:83], v[20:23], v[32:35], v[80:83]
    v_cvt_pk_bf16_f32 v147, v242, v243
    v_fma_f32 v244, v244, s48, -v49
    v_mfma_f32_16x16x32_bf16 v[84:87], v[20:23], v[36:39], v[84:87]
    v_exp_f32 v230, v230
    s_waitcnt lgkmcnt(4)
    v_mfma_f32_16x16x32_bf16 v[96:99], v[24:27], v[32:35], v[96:99]
    v_fma_f32 v245, v245, s48, -v49
    v_exp_f32 v231, v231
    v_mfma_f32_16x16x32_bf16 v[100:103], v[24:27], v[36:39], v[100:103]
    s_barrier
    v_cvt_pk_bf16_f32 v148, v228, v229
    v_fma_f32 v246, v246, s48, -v49
    s_waitcnt lgkmcnt(1)
    v_mfma_f32_16x16x32_bf16 v[112:115], v[28:31], v[32:35], v[112:115]
    ds_read_b128 v[32:35], v2 offset:24576
    v_exp_f32 v244, v244
    v_mfma_f32_16x16x32_bf16 v[116:119], v[28:31], v[36:39], v[116:119]
    ds_read_b128 v[36:39], v2 offset:25600
    v_fma_f32 v247, v247, s48, -v49
    v_exp_f32 v245, v245
    v_mfma_f32_16x16x32_bf16 v[72:75], v[16:19], v[40:43], v[72:75]
    v_cvt_pk_bf16_f32 v149, v230, v231
    v_fma_f32 v232, v232, s48, -v50
    s_waitcnt lgkmcnt(2)
    v_mfma_f32_16x16x32_bf16 v[76:79], v[16:19], v[44:47], v[76:79]
    v_add_u32 v8, 0x20000, v4
    v_xor_b32 v9, 32, v8
    v_xor_b32 v10, 64, v8
    v_xor_b32 v11, 96, v8
    ds_read_b64_tr_b16 v[16:17], v8 offset:0
    ds_read_b64_tr_b16 v[18:19], v8 offset:2048
    v_exp_f32 v246, v246
    v_mfma_f32_16x16x32_bf16 v[88:91], v[20:23], v[40:43], v[88:91]
    v_fma_f32 v233, v233, s48, -v50
    v_exp_f32 v247, v247
    v_mfma_f32_16x16x32_bf16 v[92:95], v[20:23], v[44:47], v[92:95]
    ds_read_b64_tr_b16 v[20:21], v9 offset:0
    ds_read_b64_tr_b16 v[22:23], v9 offset:2048
    v_mfma_f32_16x16x32_bf16 v[104:107], v[24:27], v[40:43], v[104:107]
    v_cvt_pk_bf16_f32 v150, v244, v245
    v_fma_f32 v234, v234, s48, -v50
    v_exp_f32 v232, v232
    v_mfma_f32_16x16x32_bf16 v[108:111], v[24:27], v[44:47], v[108:111]
    ds_read_b64_tr_b16 v[24:25], v10 offset:0
    ds_read_b64_tr_b16 v[26:27], v10 offset:2048
    v_fma_f32 v235, v235, s48, -v50
    v_mfma_f32_16x16x32_bf16 v[120:123], v[28:31], v[40:43], v[120:123]
    ds_read_b128 v[40:43], v2 offset:26624
    v_exp_f32 v233, v233
    v_mfma_f32_16x16x32_bf16 v[124:127], v[28:31], v[44:47], v[124:127]
    ds_read_b64_tr_b16 v[28:29], v11 offset:0
    ds_read_b64_tr_b16 v[30:31], v11 offset:2048
    v_cvt_pk_bf16_f32 v151, v246, v247
    v_fma_f32 v248, v248, s48, -v50
    s_waitcnt lgkmcnt(7)
    v_mfma_f32_16x16x32_bf16 v[64:67], v[16:19], v[32:35], v[64:67]
    ds_read_b128 v[44:47], v2 offset:27648
    v_exp_f32 v234, v234
    v_fma_f32 v249, v249, s48, -v50
    v_mfma_f32_16x16x32_bf16 v[68:71], v[16:19], v[36:39], v[68:71]
    v_exp_f32 v235, v235
    s_waitcnt lgkmcnt(6)
    v_mfma_f32_16x16x32_bf16 v[80:83], v[20:23], v[32:35], v[80:83]
    v_cvt_pk_bf16_f32 v152, v232, v233
    v_fma_f32 v250, v250, s48, -v50
    v_mfma_f32_16x16x32_bf16 v[84:87], v[20:23], v[36:39], v[84:87]
    v_exp_f32 v248, v248
    s_waitcnt lgkmcnt(4)
    v_mfma_f32_16x16x32_bf16 v[96:99], v[24:27], v[32:35], v[96:99]
    v_fma_f32 v251, v251, s48, -v50
    v_exp_f32 v249, v249
    v_mfma_f32_16x16x32_bf16 v[100:103], v[24:27], v[36:39], v[100:103]
    s_barrier
    v_cvt_pk_bf16_f32 v153, v234, v235
    v_fma_f32 v236, v236, s48, -v51
    s_waitcnt lgkmcnt(1)
    v_mfma_f32_16x16x32_bf16 v[112:115], v[28:31], v[32:35], v[112:115]
    ds_read_b128 v[32:35], v2 offset:28672
    v_exp_f32 v250, v250
    v_mfma_f32_16x16x32_bf16 v[116:119], v[28:31], v[36:39], v[116:119]
    ds_read_b128 v[36:39], v2 offset:29696
    v_fma_f32 v237, v237, s48, -v51
    v_exp_f32 v251, v251
    v_mfma_f32_16x16x32_bf16 v[72:75], v[16:19], v[40:43], v[72:75]
    v_cvt_pk_bf16_f32 v154, v248, v249
    v_fma_f32 v238, v238, s48, -v51
    s_waitcnt lgkmcnt(2)
    v_mfma_f32_16x16x32_bf16 v[76:79], v[16:19], v[44:47], v[76:79]
    v_add_u32 v8, 0x24000, v4
    v_xor_b32 v9, 32, v8
    v_xor_b32 v10, 64, v8
    v_xor_b32 v11, 96, v8
    ds_read_b64_tr_b16 v[16:17], v8 offset:0
    ds_read_b64_tr_b16 v[18:19], v8 offset:2048
    v_exp_f32 v236, v236
    v_mfma_f32_16x16x32_bf16 v[88:91], v[20:23], v[40:43], v[88:91]
    v_fma_f32 v239, v239, s48, -v51
    v_exp_f32 v237, v237
    v_mfma_f32_16x16x32_bf16 v[92:95], v[20:23], v[44:47], v[92:95]
    ds_read_b64_tr_b16 v[20:21], v9 offset:0
    ds_read_b64_tr_b16 v[22:23], v9 offset:2048
    v_cvt_pk_bf16_f32 v155, v250, v251
    v_mfma_f32_16x16x32_bf16 v[104:107], v[24:27], v[40:43], v[104:107]
    v_fma_f32 v252, v252, s48, -v51
    v_exp_f32 v238, v238
    v_mfma_f32_16x16x32_bf16 v[108:111], v[24:27], v[44:47], v[108:111]
    ds_read_b64_tr_b16 v[24:25], v10 offset:0
    ds_read_b64_tr_b16 v[26:27], v10 offset:2048
    v_fma_f32 v253, v253, s48, -v51
    v_mfma_f32_16x16x32_bf16 v[120:123], v[28:31], v[40:43], v[120:123]
    ds_read_b128 v[40:43], v2 offset:30720
    v_exp_f32 v239, v239
    v_mfma_f32_16x16x32_bf16 v[124:127], v[28:31], v[44:47], v[124:127]
    ds_read_b64_tr_b16 v[28:29], v11 offset:0
    ds_read_b64_tr_b16 v[30:31], v11 offset:2048
    v_cvt_pk_bf16_f32 v156, v236, v237
    v_fma_f32 v254, v254, s48, -v51
    v_exp_f32 v252, v252
    s_waitcnt lgkmcnt(7)
    v_mfma_f32_16x16x32_bf16 v[64:67], v[16:19], v[32:35], v[64:67]
    ds_read_b128 v[44:47], v2 offset:31744
    v_fma_f32 v255, v255, s48, -v51
    v_mfma_f32_16x16x32_bf16 v[68:71], v[16:19], v[36:39], v[68:71]
    v_exp_f32 v253, v253
    s_waitcnt lgkmcnt(6)
    v_mfma_f32_16x16x32_bf16 v[80:83], v[20:23], v[32:35], v[80:83]
    v_cvt_pk_bf16_f32 v157, v238, v239
    v_exp_f32 v254, v254
    v_mfma_f32_16x16x32_bf16 v[84:87], v[20:23], v[36:39], v[84:87]
    v_exp_f32 v255, v255
    s_waitcnt lgkmcnt(4)
    v_mfma_f32_16x16x32_bf16 v[96:99], v[24:27], v[32:35], v[96:99]
    v_cvt_pk_bf16_f32 v158, v252, v253
    v_cvt_pk_bf16_f32 v159, v254, v255
    v_mfma_f32_16x16x32_bf16 v[100:103], v[24:27], v[36:39], v[100:103]
    s_waitcnt lgkmcnt(0)
    s_barrier
    ds_write_b128 v60, v[128:131] offset:0
    ds_write_b128 v60, v[132:135] offset:1024
    ds_write_b128 v60, v[136:139] offset:2048
    ds_write_b128 v60, v[140:143] offset:3072
    ds_write_b128 v60, v[144:147] offset:16384
    ds_write_b128 v60, v[148:151] offset:17408
    ds_write_b128 v60, v[152:155] offset:18432
    ds_write_b128 v60, v[156:159] offset:19456
    v_mfma_f32_16x16x32_bf16 v[112:115], v[28:31], v[32:35], v[112:115]
    v_mfma_f32_16x16x32_bf16 v[116:119], v[28:31], v[36:39], v[116:119]
    v_mfma_f32_16x16x32_bf16 v[72:75], v[16:19], v[40:43], v[72:75]
    v_mfma_f32_16x16x32_bf16 v[76:79], v[16:19], v[44:47], v[76:79]
    v_mfma_f32_16x16x32_bf16 v[88:91], v[20:23], v[40:43], v[88:91]
    s_waitcnt lgkmcnt(0)
    s_barrier
    ds_read_b128 v[32:35], v2 offset:0
    ds_read_b128 v[36:39], v2 offset:1024
    v_mfma_f32_16x16x32_bf16 v[92:95], v[20:23], v[44:47], v[92:95]
    v_add_u32 v8, 0x10000, v4
    v_xor_b32 v9, 32, v8
    v_xor_b32 v10, 64, v8
    v_xor_b32 v11, 96, v8
    ds_read_b64_tr_b16 v[16:17], v8 offset:0
    ds_read_b64_tr_b16 v[18:19], v8 offset:2048
    v_mfma_f32_16x16x32_bf16 v[104:107], v[24:27], v[40:43], v[104:107]
    ds_read_b64_tr_b16 v[20:21], v9 offset:0
    ds_read_b64_tr_b16 v[22:23], v9 offset:2048
    v_mfma_f32_16x16x32_bf16 v[108:111], v[24:27], v[44:47], v[108:111]
    ds_read_b64_tr_b16 v[24:25], v10 offset:0
    ds_read_b64_tr_b16 v[26:27], v10 offset:2048
    v_mfma_f32_16x16x32_bf16 v[120:123], v[28:31], v[40:43], v[120:123]
    ds_read_b128 v[40:43], v2 offset:2048
    v_mfma_f32_16x16x32_bf16 v[124:127], v[28:31], v[44:47], v[124:127]
    ds_read_b64_tr_b16 v[28:29], v11 offset:0
    ds_read_b64_tr_b16 v[30:31], v11 offset:2048
    s_waitcnt lgkmcnt(7)
    v_mfma_f32_16x16x32_bf16 v[64:67], v[16:19], v[32:35], v[64:67]
    ds_read_b128 v[44:47], v2 offset:3072
    v_mfma_f32_16x16x32_bf16 v[68:71], v[16:19], v[36:39], v[68:71]
    s_waitcnt lgkmcnt(6)
    v_mfma_f32_16x16x32_bf16 v[80:83], v[20:23], v[32:35], v[80:83]
    v_mfma_f32_16x16x32_bf16 v[84:87], v[20:23], v[36:39], v[84:87]
    s_waitcnt lgkmcnt(4)
    v_mfma_f32_16x16x32_bf16 v[96:99], v[24:27], v[32:35], v[96:99]
    v_add_f32 v52, v52, v160
    v_mfma_f32_16x16x32_bf16 v[100:103], v[24:27], v[36:39], v[100:103]
    s_barrier
    v_add_f32 v53, v53, v164
    s_waitcnt lgkmcnt(1)
    v_mfma_f32_16x16x32_bf16 v[112:115], v[28:31], v[32:35], v[112:115]
    ds_read_b128 v[32:35], v2 offset:4096
    v_add_f32 v54, v54, v168
    v_mfma_f32_16x16x32_bf16 v[116:119], v[28:31], v[36:39], v[116:119]
    ds_read_b128 v[36:39], v2 offset:5120
    v_add_f32 v55, v55, v172
    v_mfma_f32_16x16x32_bf16 v[72:75], v[16:19], v[40:43], v[72:75]
    v_add_f32 v52, v52, v161
    s_waitcnt lgkmcnt(2)
    v_mfma_f32_16x16x32_bf16 v[76:79], v[16:19], v[44:47], v[76:79]
    v_add_u32 v8, 0x14000, v4
    v_xor_b32 v9, 32, v8
    v_xor_b32 v10, 64, v8
    v_xor_b32 v11, 96, v8
    ds_read_b64_tr_b16 v[16:17], v8 offset:0
    ds_read_b64_tr_b16 v[18:19], v8 offset:2048
    v_mfma_f32_16x16x32_bf16 v[88:91], v[20:23], v[40:43], v[88:91]
    v_add_f32 v53, v53, v165
    v_add_f32 v54, v54, v169
    v_mfma_f32_16x16x32_bf16 v[92:95], v[20:23], v[44:47], v[92:95]
    ds_read_b64_tr_b16 v[20:21], v9 offset:0
    ds_read_b64_tr_b16 v[22:23], v9 offset:2048
    v_mfma_f32_16x16x32_bf16 v[104:107], v[24:27], v[40:43], v[104:107]
    v_add_f32 v55, v55, v173
    v_add_f32 v52, v52, v162
    v_mfma_f32_16x16x32_bf16 v[108:111], v[24:27], v[44:47], v[108:111]
    ds_read_b64_tr_b16 v[24:25], v10 offset:0
    ds_read_b64_tr_b16 v[26:27], v10 offset:2048
    v_mfma_f32_16x16x32_bf16 v[120:123], v[28:31], v[40:43], v[120:123]
    ds_read_b128 v[40:43], v2 offset:6144
    v_add_f32 v53, v53, v166
    v_mfma_f32_16x16x32_bf16 v[124:127], v[28:31], v[44:47], v[124:127]
    ds_read_b64_tr_b16 v[28:29], v11 offset:0
    ds_read_b64_tr_b16 v[30:31], v11 offset:2048
    s_waitcnt lgkmcnt(7)
    v_mfma_f32_16x16x32_bf16 v[64:67], v[16:19], v[32:35], v[64:67]
    ds_read_b128 v[44:47], v2 offset:7168
    v_add_f32 v54, v54, v170
    v_mfma_f32_16x16x32_bf16 v[68:71], v[16:19], v[36:39], v[68:71]
    v_add_f32 v55, v55, v174
    v_add_f32 v52, v52, v163
    s_waitcnt lgkmcnt(6)
    v_mfma_f32_16x16x32_bf16 v[80:83], v[20:23], v[32:35], v[80:83]
    v_add_f32 v53, v53, v167
    v_mfma_f32_16x16x32_bf16 v[84:87], v[20:23], v[36:39], v[84:87]
    v_add_f32 v54, v54, v171
    s_waitcnt lgkmcnt(4)
    v_mfma_f32_16x16x32_bf16 v[96:99], v[24:27], v[32:35], v[96:99]
    v_add_f32 v55, v55, v175
    v_mfma_f32_16x16x32_bf16 v[100:103], v[24:27], v[36:39], v[100:103]
    s_barrier
    v_add_f32 v52, v52, v176
    s_waitcnt lgkmcnt(1)
    v_mfma_f32_16x16x32_bf16 v[112:115], v[28:31], v[32:35], v[112:115]
    ds_read_b128 v[32:35], v2 offset:8192
    v_add_f32 v53, v53, v180
    v_mfma_f32_16x16x32_bf16 v[116:119], v[28:31], v[36:39], v[116:119]
    ds_read_b128 v[36:39], v2 offset:9216
    v_add_f32 v54, v54, v184
    v_mfma_f32_16x16x32_bf16 v[72:75], v[16:19], v[40:43], v[72:75]
    v_add_f32 v55, v55, v188
    s_waitcnt lgkmcnt(2)
    v_mfma_f32_16x16x32_bf16 v[76:79], v[16:19], v[44:47], v[76:79]
    v_add_u32 v8, 0x18000, v4
    v_xor_b32 v9, 32, v8
    v_xor_b32 v10, 64, v8
    v_xor_b32 v11, 96, v8
    ds_read_b64_tr_b16 v[16:17], v8 offset:0
    ds_read_b64_tr_b16 v[18:19], v8 offset:2048
    v_mfma_f32_16x16x32_bf16 v[88:91], v[20:23], v[40:43], v[88:91]
    v_add_f32 v52, v52, v177
    v_add_f32 v53, v53, v181
    v_mfma_f32_16x16x32_bf16 v[92:95], v[20:23], v[44:47], v[92:95]
    ds_read_b64_tr_b16 v[20:21], v9 offset:0
    ds_read_b64_tr_b16 v[22:23], v9 offset:2048
    v_mfma_f32_16x16x32_bf16 v[104:107], v[24:27], v[40:43], v[104:107]
    v_add_f32 v54, v54, v185
    v_add_f32 v55, v55, v189
    v_mfma_f32_16x16x32_bf16 v[108:111], v[24:27], v[44:47], v[108:111]
    ds_read_b64_tr_b16 v[24:25], v10 offset:0
    ds_read_b64_tr_b16 v[26:27], v10 offset:2048
    v_mfma_f32_16x16x32_bf16 v[120:123], v[28:31], v[40:43], v[120:123]
    ds_read_b128 v[40:43], v2 offset:10240
    v_add_f32 v52, v52, v178
    v_mfma_f32_16x16x32_bf16 v[124:127], v[28:31], v[44:47], v[124:127]
    ds_read_b64_tr_b16 v[28:29], v11 offset:0
    ds_read_b64_tr_b16 v[30:31], v11 offset:2048
    s_waitcnt lgkmcnt(7)
    v_mfma_f32_16x16x32_bf16 v[64:67], v[16:19], v[32:35], v[64:67]
    ds_read_b128 v[44:47], v2 offset:11264
    v_add_f32 v53, v53, v182
    v_mfma_f32_16x16x32_bf16 v[68:71], v[16:19], v[36:39], v[68:71]
    v_add_f32 v54, v54, v186
    v_add_f32 v55, v55, v190
    s_waitcnt lgkmcnt(6)
    v_mfma_f32_16x16x32_bf16 v[80:83], v[20:23], v[32:35], v[80:83]
    v_add_f32 v52, v52, v179
    v_add_f32 v53, v53, v183
    v_mfma_f32_16x16x32_bf16 v[84:87], v[20:23], v[36:39], v[84:87]
    v_add_f32 v54, v54, v187
    s_waitcnt lgkmcnt(4)
    v_mfma_f32_16x16x32_bf16 v[96:99], v[24:27], v[32:35], v[96:99]
    v_mfma_f32_16x16x32_bf16 v[100:103], v[24:27], v[36:39], v[100:103]
    s_barrier
    v_add_f32 v55, v55, v191
    s_waitcnt lgkmcnt(1)
    v_mfma_f32_16x16x32_bf16 v[112:115], v[28:31], v[32:35], v[112:115]
    ds_read_b128 v[32:35], v2 offset:12288
    v_add_f32 v52, v52, v192
    v_mfma_f32_16x16x32_bf16 v[116:119], v[28:31], v[36:39], v[116:119]
    ds_read_b128 v[36:39], v2 offset:13312
    v_add_f32 v53, v53, v196
    v_mfma_f32_16x16x32_bf16 v[72:75], v[16:19], v[40:43], v[72:75]
    v_add_f32 v54, v54, v200
    s_waitcnt lgkmcnt(2)
    v_mfma_f32_16x16x32_bf16 v[76:79], v[16:19], v[44:47], v[76:79]
    v_add_u32 v8, 0x1c000, v4
    v_xor_b32 v9, 32, v8
    v_xor_b32 v10, 64, v8
    v_xor_b32 v11, 96, v8
    ds_read_b64_tr_b16 v[16:17], v8 offset:0
    ds_read_b64_tr_b16 v[18:19], v8 offset:2048
    v_mfma_f32_16x16x32_bf16 v[88:91], v[20:23], v[40:43], v[88:91]
    v_add_f32 v55, v55, v204
    v_add_f32 v52, v52, v193
    v_mfma_f32_16x16x32_bf16 v[92:95], v[20:23], v[44:47], v[92:95]
    ds_read_b64_tr_b16 v[20:21], v9 offset:0
    ds_read_b64_tr_b16 v[22:23], v9 offset:2048
    v_mfma_f32_16x16x32_bf16 v[104:107], v[24:27], v[40:43], v[104:107]
    v_add_f32 v53, v53, v197
    v_add_f32 v54, v54, v201
    v_mfma_f32_16x16x32_bf16 v[108:111], v[24:27], v[44:47], v[108:111]
    ds_read_b64_tr_b16 v[24:25], v10 offset:0
    ds_read_b64_tr_b16 v[26:27], v10 offset:2048
    v_mfma_f32_16x16x32_bf16 v[120:123], v[28:31], v[40:43], v[120:123]
    ds_read_b128 v[40:43], v2 offset:14336
    v_add_f32 v55, v55, v205
    v_mfma_f32_16x16x32_bf16 v[124:127], v[28:31], v[44:47], v[124:127]
    ds_read_b64_tr_b16 v[28:29], v11 offset:0
    ds_read_b64_tr_b16 v[30:31], v11 offset:2048
    v_add_f32 v52, v52, v194
    s_waitcnt lgkmcnt(7)
    v_mfma_f32_16x16x32_bf16 v[64:67], v[16:19], v[32:35], v[64:67]
    ds_read_b128 v[44:47], v2 offset:15360
    v_add_f32 v53, v53, v198
    v_mfma_f32_16x16x32_bf16 v[68:71], v[16:19], v[36:39], v[68:71]
    v_add_f32 v54, v54, v202
    v_add_f32 v55, v55, v206
    s_waitcnt lgkmcnt(6)
    v_mfma_f32_16x16x32_bf16 v[80:83], v[20:23], v[32:35], v[80:83]
    v_add_f32 v52, v52, v195
    v_mfma_f32_16x16x32_bf16 v[84:87], v[20:23], v[36:39], v[84:87]
    v_add_f32 v53, v53, v199
    s_waitcnt lgkmcnt(4)
    v_mfma_f32_16x16x32_bf16 v[96:99], v[24:27], v[32:35], v[96:99]
    v_add_f32 v54, v54, v203
    v_mfma_f32_16x16x32_bf16 v[100:103], v[24:27], v[36:39], v[100:103]
    s_barrier
    v_add_f32 v55, v55, v207
    s_waitcnt lgkmcnt(1)
    v_mfma_f32_16x16x32_bf16 v[112:115], v[28:31], v[32:35], v[112:115]
    ds_read_b128 v[32:35], v2 offset:16384
    v_add_f32 v52, v52, v208
    v_mfma_f32_16x16x32_bf16 v[116:119], v[28:31], v[36:39], v[116:119]
    ds_read_b128 v[36:39], v2 offset:17408
    v_add_f32 v53, v53, v212
    v_mfma_f32_16x16x32_bf16 v[72:75], v[16:19], v[40:43], v[72:75]
    v_add_f32 v54, v54, v216
    s_waitcnt lgkmcnt(2)
    v_mfma_f32_16x16x32_bf16 v[76:79], v[16:19], v[44:47], v[76:79]
    v_add_u32 v8, 0x8000, v4
    v_xor_b32 v9, 32, v8
    v_xor_b32 v10, 64, v8
    v_xor_b32 v11, 96, v8
    ds_read_b64_tr_b16 v[16:17], v8 offset:0
    ds_read_b64_tr_b16 v[18:19], v8 offset:2048
    v_mfma_f32_16x16x32_bf16 v[88:91], v[20:23], v[40:43], v[88:91]
    v_add_f32 v55, v55, v220
    v_mfma_f32_16x16x32_bf16 v[92:95], v[20:23], v[44:47], v[92:95]
    ds_read_b64_tr_b16 v[20:21], v9 offset:0
    ds_read_b64_tr_b16 v[22:23], v9 offset:2048
    v_mfma_f32_16x16x32_bf16 v[104:107], v[24:27], v[40:43], v[104:107]
    v_add_f32 v52, v52, v209
    v_add_f32 v53, v53, v213
    v_mfma_f32_16x16x32_bf16 v[108:111], v[24:27], v[44:47], v[108:111]
    ds_read_b64_tr_b16 v[24:25], v10 offset:0
    ds_read_b64_tr_b16 v[26:27], v10 offset:2048
    v_mfma_f32_16x16x32_bf16 v[120:123], v[28:31], v[40:43], v[120:123]
    ds_read_b128 v[40:43], v2 offset:18432
    v_add_f32 v54, v54, v217
    v_mfma_f32_16x16x32_bf16 v[124:127], v[28:31], v[44:47], v[124:127]
    ds_read_b64_tr_b16 v[28:29], v11 offset:0
    ds_read_b64_tr_b16 v[30:31], v11 offset:2048
    v_add_f32 v55, v55, v221
    s_waitcnt lgkmcnt(7)
    v_mfma_f32_16x16x32_bf16 v[64:67], v[16:19], v[32:35], v[64:67]
    ds_read_b128 v[44:47], v2 offset:19456
    v_add_f32 v52, v52, v210
    v_mfma_f32_16x16x32_bf16 v[68:71], v[16:19], v[36:39], v[68:71]
    v_add_f32 v53, v53, v214
    v_add_f32 v54, v54, v218
    s_waitcnt lgkmcnt(6)
    v_mfma_f32_16x16x32_bf16 v[80:83], v[20:23], v[32:35], v[80:83]
    v_add_f32 v55, v55, v222
    v_mfma_f32_16x16x32_bf16 v[84:87], v[20:23], v[36:39], v[84:87]
    v_add_f32 v52, v52, v211
    s_waitcnt lgkmcnt(4)
    v_mfma_f32_16x16x32_bf16 v[96:99], v[24:27], v[32:35], v[96:99]
    v_add_f32 v53, v53, v215
    v_mfma_f32_16x16x32_bf16 v[100:103], v[24:27], v[36:39], v[100:103]
    s_barrier
    v_add_f32 v54, v54, v219
    s_waitcnt lgkmcnt(1)
    v_mfma_f32_16x16x32_bf16 v[112:115], v[28:31], v[32:35], v[112:115]
    ds_read_b128 v[32:35], v2 offset:20480
    v_add_f32 v55, v55, v223
    v_mfma_f32_16x16x32_bf16 v[116:119], v[28:31], v[36:39], v[116:119]
    ds_read_b128 v[36:39], v2 offset:21504
    v_add_f32 v52, v52, v224
    v_mfma_f32_16x16x32_bf16 v[72:75], v[16:19], v[40:43], v[72:75]
    v_add_f32 v53, v53, v228
    s_waitcnt lgkmcnt(2)
    v_mfma_f32_16x16x32_bf16 v[76:79], v[16:19], v[44:47], v[76:79]
    v_add_u32 v8, 0xc000, v4
    v_xor_b32 v9, 32, v8
    v_xor_b32 v10, 64, v8
    v_xor_b32 v11, 96, v8
    ds_read_b64_tr_b16 v[16:17], v8 offset:0
    ds_read_b64_tr_b16 v[18:19], v8 offset:2048
    v_mfma_f32_16x16x32_bf16 v[88:91], v[20:23], v[40:43], v[88:91]
    v_add_f32 v54, v54, v232
    v_add_f32 v55, v55, v236
    v_mfma_f32_16x16x32_bf16 v[92:95], v[20:23], v[44:47], v[92:95]
    ds_read_b64_tr_b16 v[20:21], v9 offset:0
    ds_read_b64_tr_b16 v[22:23], v9 offset:2048
    v_mfma_f32_16x16x32_bf16 v[104:107], v[24:27], v[40:43], v[104:107]
    v_add_f32 v52, v52, v225
    v_add_f32 v53, v53, v229
    v_mfma_f32_16x16x32_bf16 v[108:111], v[24:27], v[44:47], v[108:111]
    ds_read_b64_tr_b16 v[24:25], v10 offset:0
    ds_read_b64_tr_b16 v[26:27], v10 offset:2048
    v_mfma_f32_16x16x32_bf16 v[120:123], v[28:31], v[40:43], v[120:123]
    ds_read_b128 v[40:43], v2 offset:22528
    v_add_f32 v54, v54, v233
    v_mfma_f32_16x16x32_bf16 v[124:127], v[28:31], v[44:47], v[124:127]
    ds_read_b64_tr_b16 v[28:29], v11 offset:0
    ds_read_b64_tr_b16 v[30:31], v11 offset:2048
    s_waitcnt lgkmcnt(7)
    v_mfma_f32_16x16x32_bf16 v[64:67], v[16:19], v[32:35], v[64:67]
    ds_read_b128 v[44:47], v2 offset:23552
    v_add_f32 v55, v55, v237
    v_mfma_f32_16x16x32_bf16 v[68:71], v[16:19], v[36:39], v[68:71]
    v_add_f32 v52, v52, v226
    v_add_f32 v53, v53, v230
    s_waitcnt lgkmcnt(6)
    v_mfma_f32_16x16x32_bf16 v[80:83], v[20:23], v[32:35], v[80:83]
    v_add_f32 v54, v54, v234
    v_bfe_u32 v3, v0, 2, 2
    v_mfma_f32_16x16x32_bf16 v[84:87], v[20:23], v[36:39], v[84:87]
    v_add_f32 v55, v55, v238
    s_waitcnt lgkmcnt(4)
    v_mfma_f32_16x16x32_bf16 v[96:99], v[24:27], v[32:35], v[96:99]
    v_add_f32 v52, v52, v227
    v_lshlrev_b32 v3, 7, v3
    v_mfma_f32_16x16x32_bf16 v[100:103], v[24:27], v[36:39], v[100:103]
    s_barrier
    v_add_f32 v53, v53, v231
    s_waitcnt lgkmcnt(1)
    v_mfma_f32_16x16x32_bf16 v[112:115], v[28:31], v[32:35], v[112:115]
    ds_read_b128 v[32:35], v2 offset:24576
    v_add_f32 v54, v54, v235
    v_mfma_f32_16x16x32_bf16 v[116:119], v[28:31], v[36:39], v[116:119]
    ds_read_b128 v[36:39], v2 offset:25600
    v_add_f32 v55, v55, v239
    v_mfma_f32_16x16x32_bf16 v[72:75], v[16:19], v[40:43], v[72:75]
    v_add_f32 v52, v52, v240
    v_lshrrev_b32 v1, 4, v0
    s_waitcnt lgkmcnt(2)
    v_mfma_f32_16x16x32_bf16 v[76:79], v[16:19], v[44:47], v[76:79]
    v_add_u32 v8, 0x20000, v4
    v_xor_b32 v9, 32, v8
    v_xor_b32 v10, 64, v8
    v_xor_b32 v11, 96, v8
    ds_read_b64_tr_b16 v[16:17], v8 offset:0
    ds_read_b64_tr_b16 v[18:19], v8 offset:2048
    v_mfma_f32_16x16x32_bf16 v[88:91], v[20:23], v[40:43], v[88:91]
    v_add_f32 v53, v53, v244
    v_add_f32 v54, v54, v248
    v_mfma_f32_16x16x32_bf16 v[92:95], v[20:23], v[44:47], v[92:95]
    ds_read_b64_tr_b16 v[20:21], v9 offset:0
    ds_read_b64_tr_b16 v[22:23], v9 offset:2048
    v_mfma_f32_16x16x32_bf16 v[104:107], v[24:27], v[40:43], v[104:107]
    v_add_f32 v55, v55, v252
    v_add_f32 v52, v52, v241
    v_mfma_f32_16x16x32_bf16 v[108:111], v[24:27], v[44:47], v[108:111]
    ds_read_b64_tr_b16 v[24:25], v10 offset:0
    ds_read_b64_tr_b16 v[26:27], v10 offset:2048
    v_mfma_f32_16x16x32_bf16 v[120:123], v[28:31], v[40:43], v[120:123]
    ds_read_b128 v[40:43], v2 offset:26624
    v_add_f32 v53, v53, v245
    v_lshl_add_u32 v3, v1, 9, v3
    v_mfma_f32_16x16x32_bf16 v[124:127], v[28:31], v[44:47], v[124:127]
    ds_read_b64_tr_b16 v[28:29], v11 offset:0
    ds_read_b64_tr_b16 v[30:31], v11 offset:2048
    s_waitcnt lgkmcnt(7)
    v_mfma_f32_16x16x32_bf16 v[64:67], v[16:19], v[32:35], v[64:67]
    ds_read_b128 v[44:47], v2 offset:27648
    v_add_f32 v54, v54, v249
    v_add_f32 v55, v55, v253
    v_and_b32 v1, 3, v0
    v_mfma_f32_16x16x32_bf16 v[68:71], v[16:19], v[36:39], v[68:71]
    v_add_f32 v52, v52, v242
    v_add_f32 v53, v53, v246
    s_waitcnt lgkmcnt(6)
    v_mfma_f32_16x16x32_bf16 v[80:83], v[20:23], v[32:35], v[80:83]
    v_add_f32 v54, v54, v250
    v_lshl_add_u32 v3, v1, 3, v3
    v_mfma_f32_16x16x32_bf16 v[84:87], v[20:23], v[36:39], v[84:87]
    v_add_f32 v55, v55, v254
    v_bfe_u32 v1, v0, 3, 2
    s_waitcnt lgkmcnt(4)
    v_mfma_f32_16x16x32_bf16 v[96:99], v[24:27], v[32:35], v[96:99]
    v_add_f32 v52, v52, v243
    v_lshl_add_u32 v56, v1, 5, v3
    v_mfma_f32_16x16x32_bf16 v[100:103], v[24:27], v[36:39], v[100:103]
    s_barrier
    s_waitcnt lgkmcnt(1)
    v_mfma_f32_16x16x32_bf16 v[112:115], v[28:31], v[32:35], v[112:115]
    ds_read_b128 v[32:35], v2 offset:28672
    v_add_f32 v53, v53, v247
    v_mfma_f32_16x16x32_bf16 v[116:119], v[28:31], v[36:39], v[116:119]
    ds_read_b128 v[36:39], v2 offset:29696
    v_add_f32 v54, v54, v251
    v_mfma_f32_16x16x32_bf16 v[72:75], v[16:19], v[40:43], v[72:75]
    v_add_f32 v55, v55, v255
    s_lshl_b32 s50, s3, 5
    s_waitcnt lgkmcnt(2)
    v_mfma_f32_16x16x32_bf16 v[76:79], v[16:19], v[44:47], v[76:79]
    v_add_u32 v8, 0x24000, v4
    v_xor_b32 v9, 32, v8
    v_xor_b32 v10, 64, v8
    v_xor_b32 v11, 96, v8
    ds_read_b64_tr_b16 v[16:17], v8 offset:0
    ds_read_b64_tr_b16 v[18:19], v8 offset:2048
    v_mfma_f32_16x16x32_bf16 v[88:91], v[20:23], v[40:43], v[88:91]
    v_xor_b32 v56, s50, v56
    v_mfma_f32_16x16x32_bf16 v[92:95], v[20:23], v[44:47], v[92:95]
    ds_read_b64_tr_b16 v[20:21], v9 offset:0
    ds_read_b64_tr_b16 v[22:23], v9 offset:2048
    v_mfma_f32_16x16x32_bf16 v[104:107], v[24:27], v[40:43], v[104:107]
    s_lshl_b32 s50, s3, 11
    v_mfma_f32_16x16x32_bf16 v[108:111], v[24:27], v[44:47], v[108:111]
    ds_read_b64_tr_b16 v[24:25], v10 offset:0
    ds_read_b64_tr_b16 v[26:27], v10 offset:2048
    v_mfma_f32_16x16x32_bf16 v[120:123], v[28:31], v[40:43], v[120:123]
    ds_read_b128 v[40:43], v2 offset:30720
    v_add_u32 v57, s50, v2
    v_mfma_f32_16x16x32_bf16 v[124:127], v[28:31], v[44:47], v[124:127]
    ds_read_b64_tr_b16 v[28:29], v11 offset:0
    ds_read_b64_tr_b16 v[30:31], v11 offset:2048
    s_waitcnt lgkmcnt(7)
    v_mfma_f32_16x16x32_bf16 v[64:67], v[16:19], v[32:35], v[64:67]
    ds_read_b128 v[44:47], v2 offset:31744
    v_mfma_f32_16x16x32_bf16 v[68:71], v[16:19], v[36:39], v[68:71]
    s_waitcnt lgkmcnt(6)
    v_mfma_f32_16x16x32_bf16 v[80:83], v[20:23], v[32:35], v[80:83]
    v_mfma_f32_16x16x32_bf16 v[84:87], v[20:23], v[36:39], v[84:87]
    s_waitcnt lgkmcnt(4)
    v_mfma_f32_16x16x32_bf16 v[96:99], v[24:27], v[32:35], v[96:99]
    v_mfma_f32_16x16x32_bf16 v[100:103], v[24:27], v[36:39], v[100:103]
    s_waitcnt lgkmcnt(0)
    s_barrier
    v_mfma_f32_16x16x32_bf16 v[112:115], v[28:31], v[32:35], v[112:115]
    v_mfma_f32_16x16x32_bf16 v[116:119], v[28:31], v[36:39], v[116:119]
    v_mfma_f32_16x16x32_bf16 v[72:75], v[16:19], v[40:43], v[72:75]
    v_mfma_f32_16x16x32_bf16 v[76:79], v[16:19], v[44:47], v[76:79]
    v_mfma_f32_16x16x32_bf16 v[88:91], v[20:23], v[40:43], v[88:91]
    v_mfma_f32_16x16x32_bf16 v[92:95], v[20:23], v[44:47], v[92:95]
    v_mfma_f32_16x16x32_bf16 v[104:107], v[24:27], v[40:43], v[104:107]
    v_mfma_f32_16x16x32_bf16 v[108:111], v[24:27], v[44:47], v[108:111]
    v_mfma_f32_16x16x32_bf16 v[120:123], v[28:31], v[40:43], v[120:123]
    v_mfma_f32_16x16x32_bf16 v[124:127], v[28:31], v[44:47], v[124:127]
    s_nop 7
    s_nop 1
    v_mov_b32 v32, v52
    v_mov_b32 v33, v53
    v_mov_b32 v34, v54
    v_mov_b32 v35, v55
    s_nop 1
    v_permlane32_swap_b32 v52, v32
    v_permlane32_swap_b32 v53, v33
    v_permlane32_swap_b32 v54, v34
    v_permlane32_swap_b32 v55, v35
    s_nop 0
    v_add_f32 v52, v52, v32
    v_add_f32 v53, v53, v33
    v_add_f32 v54, v54, v34
    v_add_f32 v55, v55, v35
    v_mov_b32 v32, v52
    v_mov_b32 v33, v53
    v_mov_b32 v34, v54
    v_mov_b32 v35, v55
    s_nop 1
    v_permlane16_swap_b32 v52, v32
    v_permlane16_swap_b32 v53, v33
    v_permlane16_swap_b32 v54, v34
    v_permlane16_swap_b32 v55, v35
    s_nop 0
    v_add_f32 v52, v52, v32
    v_add_f32 v53, v53, v33
    v_add_f32 v54, v54, v34
    v_add_f32 v55, v55, v35
    s_mov_b64 exec, 0xffff
    ds_write_b32 v58, v52 offset:0
    ds_write_b32 v58, v53 offset:256
    ds_write_b32 v58, v54 offset:512
    ds_write_b32 v58, v55 offset:768
    s_mov_b64 exec, -1
    v_cvt_pk_bf16_f32 v64, v64, v65
    v_cvt_pk_bf16_f32 v65, v66, v67
    v_cvt_pk_bf16_f32 v66, v80, v81
    v_cvt_pk_bf16_f32 v67, v82, v83
    ds_write_b128 v7, v[64:67] offset:0
    v_cvt_pk_bf16_f32 v68, v68, v69
    v_cvt_pk_bf16_f32 v69, v70, v71
    v_cvt_pk_bf16_f32 v70, v84, v85
    v_cvt_pk_bf16_f32 v71, v86, v87
    ds_write_b128 v7, v[68:71] offset:1024
    v_cvt_pk_bf16_f32 v72, v72, v73
    v_cvt_pk_bf16_f32 v73, v74, v75
    v_cvt_pk_bf16_f32 v74, v88, v89
    v_cvt_pk_bf16_f32 v75, v90, v91
    ds_write_b128 v7, v[72:75] offset:2048
    v_cvt_pk_bf16_f32 v76, v76, v77
    v_cvt_pk_bf16_f32 v77, v78, v79
    v_cvt_pk_bf16_f32 v78, v92, v93
    v_cvt_pk_bf16_f32 v79, v94, v95
    ds_write_b128 v7, v[76:79] offset:3072
    v_cvt_pk_bf16_f32 v96, v96, v97
    v_cvt_pk_bf16_f32 v97, v98, v99
    v_cvt_pk_bf16_f32 v98, v112, v113
    v_cvt_pk_bf16_f32 v99, v114, v115
    ds_write_b128 v7, v[96:99] offset:4096
    v_cvt_pk_bf16_f32 v100, v100, v101
    v_cvt_pk_bf16_f32 v101, v102, v103
    v_cvt_pk_bf16_f32 v102, v116, v117
    v_cvt_pk_bf16_f32 v103, v118, v119
    ds_write_b128 v7, v[100:103] offset:5120
    v_cvt_pk_bf16_f32 v104, v104, v105
    v_cvt_pk_bf16_f32 v105, v106, v107
    v_cvt_pk_bf16_f32 v106, v120, v121
    v_cvt_pk_bf16_f32 v107, v122, v123
    ds_write_b128 v7, v[104:107] offset:6144
    v_cvt_pk_bf16_f32 v108, v108, v109
    v_cvt_pk_bf16_f32 v109, v110, v111
    v_cvt_pk_bf16_f32 v110, v124, v125
    v_cvt_pk_bf16_f32 v111, v126, v127
    ds_write_b128 v7, v[108:111] offset:7168
    s_waitcnt lgkmcnt(0)
    s_barrier
    v_add_u32 v8, 0x10000, v56
    ds_read_b64_tr_b16 v[16:17], v8 offset:0
    ds_read_b64_tr_b16 v[18:19], v8 offset:2048
    ds_read_b128 v[64:67], v2 offset:0
    ds_read_b128 v[68:71], v2 offset:1024
    ds_read_b128 v[72:75], v2 offset:2048
    ds_read_b128 v[76:79], v2 offset:3072
    ds_read_b64_tr_b16 v[20:21], v8 offset:4096
    ds_read_b64_tr_b16 v[22:23], v8 offset:6144
    ds_read_b128 v[80:83], v2 offset:4096
    ds_read_b128 v[84:87], v2 offset:5120
    ds_read_b128 v[88:91], v2 offset:6144
    ds_read_b128 v[92:95], v2 offset:7168
    s_waitcnt lgkmcnt(9)
    v_mfma_f32_16x16x32_bf16 v[192:195], v[16:19], v[64:67], 0
    ds_read_b64_tr_b16 v[24:25], v8 offset:8192
    ds_read_b64_tr_b16 v[26:27], v8 offset:10240
    s_waitcnt lgkmcnt(10)
    v_mfma_f32_16x16x32_bf16 v[196:199], v[16:19], v[68:71], 0
    ds_read_b128 v[96:99], v2 offset:8192
    ds_read_b128 v[100:103], v2 offset:9216
    s_waitcnt lgkmcnt(11)
    v_mfma_f32_16x16x32_bf16 v[200:203], v[16:19], v[72:75], 0
    ds_read_b128 v[104:107], v2 offset:10240
    ds_read_b128 v[108:111], v2 offset:11264
    s_waitcnt lgkmcnt(12)
    v_mfma_f32_16x16x32_bf16 v[204:207], v[16:19], v[76:79], 0
    s_barrier
    ds_read_b64_tr_b16 v[28:29], v8 offset:12288
    ds_read_b64_tr_b16 v[30:31], v8 offset:14336
    s_waitcnt lgkmcnt(11)
    v_mfma_f32_16x16x32_bf16 v[192:195], v[20:23], v[80:83], v[192:195]
    ds_read_b128 v[112:115], v2 offset:12288
    ds_read_b128 v[116:119], v2 offset:13312
    s_waitcnt lgkmcnt(12)
    v_mfma_f32_16x16x32_bf16 v[196:199], v[20:23], v[84:87], v[196:199]
    ds_read_b128 v[120:123], v2 offset:14336
    ds_read_b128 v[124:127], v2 offset:15360
    s_waitcnt lgkmcnt(13)
    v_mfma_f32_16x16x32_bf16 v[200:203], v[20:23], v[88:91], v[200:203]
    v_add_u32 v8, 0x14000, v56
    ds_read_b64_tr_b16 v[32:33], v8 offset:0
    ds_read_b64_tr_b16 v[34:35], v8 offset:2048
    s_waitcnt lgkmcnt(14)
    v_mfma_f32_16x16x32_bf16 v[204:207], v[20:23], v[92:95], v[204:207]
    ds_read_b128 v[128:131], v2 offset:16384
    ds_read_b128 v[132:135], v2 offset:17408
    s_waitcnt lgkmcnt(13)
    v_mfma_f32_16x16x32_bf16 v[192:195], v[24:27], v[96:99], v[192:195]
    ds_read_b128 v[136:139], v2 offset:18432
    ds_read_b128 v[140:143], v2 offset:19456
    s_waitcnt lgkmcnt(14)
    v_mfma_f32_16x16x32_bf16 v[196:199], v[24:27], v[100:103], v[196:199]
    ds_read_b64_tr_b16 v[36:37], v8 offset:4096
    ds_read_b64_tr_b16 v[38:39], v8 offset:6144
    ds_read_b128 v[224:227], v59 offset:0
    ds_read_b128 v[228:231], v59 offset:256
    ds_read_b128 v[232:235], v59 offset:512
    ds_read_b128 v[236:239], v59 offset:768
    s_waitcnt lgkmcnt(15)
    v_mfma_f32_16x16x32_bf16 v[200:203], v[24:27], v[104:107], v[200:203]
    ds_read_b128 v[144:147], v2 offset:20480
    ds_read_b128 v[148:151], v2 offset:21504
    v_mfma_f32_16x16x32_bf16 v[204:207], v[24:27], v[108:111], v[204:207]
    ds_read_b128 v[152:155], v2 offset:22528
    ds_read_b128 v[156:159], v2 offset:23552
    v_mfma_f32_16x16x32_bf16 v[192:195], v[28:31], v[112:115], v[192:195]
    ds_read_b64_tr_b16 v[40:41], v8 offset:8192
    ds_read_b64_tr_b16 v[42:43], v8 offset:10240
    s_waitcnt lgkmcnt(15)
    v_mfma_f32_16x16x32_bf16 v[196:199], v[28:31], v[116:119], v[196:199]
    ds_read_b128 v[160:163], v2 offset:24576
    ds_read_b128 v[164:167], v2 offset:25600
    v_mfma_f32_16x16x32_bf16 v[200:203], v[28:31], v[120:123], v[200:203]
    ds_read_b128 v[168:171], v2 offset:26624
    ds_read_b128 v[172:175], v2 offset:27648
    v_mfma_f32_16x16x32_bf16 v[204:207], v[28:31], v[124:127], v[204:207]
    ds_read_b64_tr_b16 v[44:45], v8 offset:12288
    ds_read_b64_tr_b16 v[46:47], v8 offset:14336
    v_mfma_f32_16x16x32_bf16 v[192:195], v[32:35], v[128:131], v[192:195]
    ds_read_b128 v[176:179], v2 offset:28672
    ds_read_b128 v[180:183], v2 offset:29696
    s_waitcnt lgkmcnt(15)
    v_mfma_f32_16x16x32_bf16 v[196:199], v[32:35], v[132:135], v[196:199]
    ds_read_b128 v[184:187], v2 offset:30720
    ds_read_b128 v[188:191], v2 offset:31744
    v_mfma_f32_16x16x32_bf16 v[200:203], v[32:35], v[136:139], v[200:203]
    v_mfma_f32_16x16x32_bf16 v[204:207], v[32:35], v[140:143], v[204:207]
    s_barrier
    v_add_u32 v8, 0x18000, v56
    ds_read_b64_tr_b16 v[16:17], v8 offset:0
    ds_read_b64_tr_b16 v[18:19], v8 offset:2048
    s_waitcnt lgkmcnt(15)
    v_mfma_f32_16x16x32_bf16 v[192:195], v[36:39], v[144:147], v[192:195]
    ds_read_b64_tr_b16 v[20:21], v8 offset:4096
    ds_read_b64_tr_b16 v[22:23], v8 offset:6144
    v_mfma_f32_16x16x32_bf16 v[196:199], v[36:39], v[148:151], v[196:199]
    ds_read_b64_tr_b16 v[24:25], v8 offset:8192
    ds_read_b64_tr_b16 v[26:27], v8 offset:10240
    v_mfma_f32_16x16x32_bf16 v[200:203], v[36:39], v[152:155], v[200:203]
    ds_read_b64_tr_b16 v[28:29], v8 offset:12288
    ds_read_b64_tr_b16 v[30:31], v8 offset:14336
    v_add_f32 v224, v224, v225
    v_add_f32 v228, v228, v229
    s_waitcnt lgkmcnt(15)
    v_mfma_f32_16x16x32_bf16 v[204:207], v[36:39], v[156:159], v[204:207]
    v_add_f32 v232, v232, v233
    v_add_f32 v236, v236, v237
    v_mfma_f32_16x16x32_bf16 v[192:195], v[40:43], v[160:163], v[192:195]
    v_add_f32 v224, v224, v226
    v_add_f32 v228, v228, v230
    v_mfma_f32_16x16x32_bf16 v[196:199], v[40:43], v[164:167], v[196:199]
    v_add_f32 v232, v232, v234
    v_add_f32 v236, v236, v238
    v_mfma_f32_16x16x32_bf16 v[200:203], v[40:43], v[168:171], v[200:203]
    v_add_f32 v224, v224, v227
    s_waitcnt lgkmcnt(14)
    v_mfma_f32_16x16x32_bf16 v[204:207], v[40:43], v[172:175], v[204:207]
    v_add_f32 v228, v228, v231
    v_add_f32 v232, v232, v235
    s_waitcnt lgkmcnt(11)
    v_mfma_f32_16x16x32_bf16 v[192:195], v[44:47], v[176:179], v[192:195]
    v_add_f32 v236, v236, v239
    s_waitcnt lgkmcnt(10)
    v_mfma_f32_16x16x32_bf16 v[196:199], v[44:47], v[180:183], v[196:199]
    v_rcp_f32 v48, v224
    s_waitcnt lgkmcnt(9)
    v_mfma_f32_16x16x32_bf16 v[200:203], v[44:47], v[184:187], v[200:203]
    s_waitcnt lgkmcnt(8)
    v_mfma_f32_16x16x32_bf16 v[204:207], v[44:47], v[188:191], v[204:207]
    v_rcp_f32 v49, v228
    s_waitcnt lgkmcnt(6)
    v_mfma_f32_16x16x32_bf16 v[208:211], v[16:19], v[64:67], 0
    v_rcp_f32 v50, v232
    v_mfma_f32_16x16x32_bf16 v[212:215], v[16:19], v[68:71], 0
    v_mfma_f32_16x16x32_bf16 v[216:219], v[16:19], v[72:75], 0
    v_rcp_f32 v51, v236
    v_mfma_f32_16x16x32_bf16 v[220:223], v[16:19], v[76:79], 0
    s_barrier
    v_add_u32 v8, 0x1c000, v56
    ds_read_b64_tr_b16 v[32:33], v8 offset:0
    ds_read_b64_tr_b16 v[34:35], v8 offset:2048
    s_waitcnt lgkmcnt(6)
    v_mfma_f32_16x16x32_bf16 v[208:211], v[20:23], v[80:83], v[208:211]
    ds_read_b64_tr_b16 v[36:37], v8 offset:4096
    ds_read_b64_tr_b16 v[38:39], v8 offset:6144
    v_mfma_f32_16x16x32_bf16 v[212:215], v[20:23], v[84:87], v[212:215]
    ds_read_b64_tr_b16 v[40:41], v8 offset:8192
    ds_read_b64_tr_b16 v[42:43], v8 offset:10240
    v_mfma_f32_16x16x32_bf16 v[216:219], v[20:23], v[88:91], v[216:219]
    ds_read_b64_tr_b16 v[44:45], v8 offset:12288
    ds_read_b64_tr_b16 v[46:47], v8 offset:14336
    v_mfma_f32_16x16x32_bf16 v[220:223], v[20:23], v[92:95], v[220:223]
    v_mul_f32 v192, v192, v48
    v_mul_f32 v193, v193, v48
    s_waitcnt lgkmcnt(10)
    v_mfma_f32_16x16x32_bf16 v[208:211], v[24:27], v[96:99], v[208:211]
    v_mul_f32 v194, v194, v48
    v_mfma_f32_16x16x32_bf16 v[212:215], v[24:27], v[100:103], v[212:215]
    v_mul_f32 v195, v195, v48
    v_mfma_f32_16x16x32_bf16 v[216:219], v[24:27], v[104:107], v[216:219]
    v_mul_f32 v196, v196, v49
    v_mul_f32 v197, v197, v49
    v_mfma_f32_16x16x32_bf16 v[220:223], v[24:27], v[108:111], v[220:223]
    v_mul_f32 v198, v198, v49
    s_waitcnt lgkmcnt(8)
    v_mfma_f32_16x16x32_bf16 v[208:211], v[28:31], v[112:115], v[208:211]
    v_mul_f32 v199, v199, v49
    v_mfma_f32_16x16x32_bf16 v[212:215], v[28:31], v[116:119], v[212:215]
    v_mul_f32 v200, v200, v50
    v_mfma_f32_16x16x32_bf16 v[216:219], v[28:31], v[120:123], v[216:219]
    v_mul_f32 v201, v201, v50
    v_mfma_f32_16x16x32_bf16 v[220:223], v[28:31], v[124:127], v[220:223]
    v_mul_f32 v202, v202, v50
    s_waitcnt lgkmcnt(6)
    v_mfma_f32_16x16x32_bf16 v[208:211], v[32:35], v[128:131], v[208:211]
    v_mul_f32 v203, v203, v50
    v_mfma_f32_16x16x32_bf16 v[212:215], v[32:35], v[132:135], v[212:215]
    v_mul_f32 v204, v204, v51
    v_mfma_f32_16x16x32_bf16 v[216:219], v[32:35], v[136:139], v[216:219]
    v_mul_f32 v205, v205, v51
    v_mfma_f32_16x16x32_bf16 v[220:223], v[32:35], v[140:143], v[220:223]
    s_barrier
    v_add_u32 v8, 0x8000, v56
    ds_read_b64_tr_b16 v[16:17], v8 offset:0
    ds_read_b64_tr_b16 v[18:19], v8 offset:2048
    s_waitcnt lgkmcnt(6)
    v_mfma_f32_16x16x32_bf16 v[208:211], v[36:39], v[144:147], v[208:211]
    ds_read_b64_tr_b16 v[20:21], v8 offset:4096
    ds_read_b64_tr_b16 v[22:23], v8 offset:6144
    v_mul_f32 v206, v206, v51
    v_mfma_f32_16x16x32_bf16 v[212:215], v[36:39], v[148:151], v[212:215]
    ds_read_b64_tr_b16 v[24:25], v8 offset:8192
    ds_read_b64_tr_b16 v[26:27], v8 offset:10240
    v_mul_f32 v207, v207, v51
    v_mfma_f32_16x16x32_bf16 v[216:219], v[36:39], v[152:155], v[216:219]
    ds_read_b64_tr_b16 v[28:29], v8 offset:12288
    ds_read_b64_tr_b16 v[30:31], v8 offset:14336
    v_cvt_pk_bf16_f32 v192, v192, v193
    v_mfma_f32_16x16x32_bf16 v[220:223], v[36:39], v[156:159], v[220:223]
    v_cvt_pk_bf16_f32 v193, v194, v195
    v_cvt_pk_bf16_f32 v194, v196, v197
    s_waitcnt lgkmcnt(10)
    v_mfma_f32_16x16x32_bf16 v[208:211], v[40:43], v[160:163], v[208:211]
    v_cvt_pk_bf16_f32 v195, v198, v199
    s_mov_b32 s54, 0
    buffer_store_dwordx4 v[192:195], v57, s[40:43], s54 offen nt
    v_cvt_pk_bf16_f32 v200, v200, v201
    v_mfma_f32_16x16x32_bf16 v[212:215], v[40:43], v[164:167], v[212:215]
    v_cvt_pk_bf16_f32 v201, v202, v203
    v_mfma_f32_16x16x32_bf16 v[216:219], v[40:43], v[168:171], v[216:219]
    v_cvt_pk_bf16_f32 v202, v204, v205
    v_mfma_f32_16x16x32_bf16 v[220:223], v[40:43], v[172:175], v[220:223]
    s_waitcnt lgkmcnt(8)
    v_mfma_f32_16x16x32_bf16 v[208:211], v[44:47], v[176:179], v[208:211]
    v_cvt_pk_bf16_f32 v203, v206, v207
    s_mov_b32 s54, 1024
    buffer_store_dwordx4 v[200:203], v57, s[40:43], s54 offen nt
    v_mfma_f32_16x16x32_bf16 v[212:215], v[44:47], v[180:183], v[212:215]
    v_mfma_f32_16x16x32_bf16 v[216:219], v[44:47], v[184:187], v[216:219]
    v_mfma_f32_16x16x32_bf16 v[220:223], v[44:47], v[188:191], v[220:223]
    s_waitcnt lgkmcnt(6)
    v_mfma_f32_16x16x32_bf16 v[192:195], v[16:19], v[64:67], 0
    v_mfma_f32_16x16x32_bf16 v[196:199], v[16:19], v[68:71], 0
    v_mfma_f32_16x16x32_bf16 v[200:203], v[16:19], v[72:75], 0
    v_mfma_f32_16x16x32_bf16 v[204:207], v[16:19], v[76:79], 0
    s_barrier
    v_add_u32 v8, 0xc000, v56
    ds_read_b64_tr_b16 v[32:33], v8 offset:0
    ds_read_b64_tr_b16 v[34:35], v8 offset:2048
    s_waitcnt lgkmcnt(6)
    v_mfma_f32_16x16x32_bf16 v[192:195], v[20:23], v[80:83], v[192:195]
    ds_read_b64_tr_b16 v[36:37], v8 offset:4096
    ds_read_b64_tr_b16 v[38:39], v8 offset:6144
    v_mfma_f32_16x16x32_bf16 v[196:199], v[20:23], v[84:87], v[196:199]
    ds_read_b64_tr_b16 v[40:41], v8 offset:8192
    ds_read_b64_tr_b16 v[42:43], v8 offset:10240
    v_mfma_f32_16x16x32_bf16 v[200:203], v[20:23], v[88:91], v[200:203]
    ds_read_b64_tr_b16 v[44:45], v8 offset:12288
    ds_read_b64_tr_b16 v[46:47], v8 offset:14336
    v_mfma_f32_16x16x32_bf16 v[204:207], v[20:23], v[92:95], v[204:207]
    v_mul_f32 v208, v208, v48
    v_mul_f32 v209, v209, v48
    s_waitcnt lgkmcnt(10)
    v_mfma_f32_16x16x32_bf16 v[192:195], v[24:27], v[96:99], v[192:195]
    v_mul_f32 v210, v210, v48
    v_mfma_f32_16x16x32_bf16 v[196:199], v[24:27], v[100:103], v[196:199]
    v_mul_f32 v211, v211, v48
    v_mfma_f32_16x16x32_bf16 v[200:203], v[24:27], v[104:107], v[200:203]
    v_mul_f32 v212, v212, v49
    v_mul_f32 v213, v213, v49
    v_mfma_f32_16x16x32_bf16 v[204:207], v[24:27], v[108:111], v[204:207]
    v_mul_f32 v214, v214, v49
    s_waitcnt lgkmcnt(8)
    v_mfma_f32_16x16x32_bf16 v[192:195], v[28:31], v[112:115], v[192:195]
    v_mul_f32 v215, v215, v49
    v_mfma_f32_16x16x32_bf16 v[196:199], v[28:31], v[116:119], v[196:199]
    v_mul_f32 v216, v216, v50
    v_mfma_f32_16x16x32_bf16 v[200:203], v[28:31], v[120:123], v[200:203]
    v_mul_f32 v217, v217, v50
    v_mfma_f32_16x16x32_bf16 v[204:207], v[28:31], v[124:127], v[204:207]
    v_mul_f32 v218, v218, v50
    s_waitcnt lgkmcnt(6)
    v_mfma_f32_16x16x32_bf16 v[192:195], v[32:35], v[128:131], v[192:195]
    v_mul_f32 v219, v219, v50
    v_mfma_f32_16x16x32_bf16 v[196:199], v[32:35], v[132:135], v[196:199]
    v_mul_f32 v220, v220, v51
    v_mfma_f32_16x16x32_bf16 v[200:203], v[32:35], v[136:139], v[200:203]
    v_mul_f32 v221, v221, v51
    v_mfma_f32_16x16x32_bf16 v[204:207], v[32:35], v[140:143], v[204:207]
    s_barrier
    v_add_u32 v8, 0x20000, v56
    ds_read_b64_tr_b16 v[16:17], v8 offset:0
    ds_read_b64_tr_b16 v[18:19], v8 offset:2048
    s_waitcnt lgkmcnt(6)
    v_mfma_f32_16x16x32_bf16 v[192:195], v[36:39], v[144:147], v[192:195]
    ds_read_b64_tr_b16 v[20:21], v8 offset:4096
    ds_read_b64_tr_b16 v[22:23], v8 offset:6144
    v_mul_f32 v222, v222, v51
    v_mfma_f32_16x16x32_bf16 v[196:199], v[36:39], v[148:151], v[196:199]
    ds_read_b64_tr_b16 v[24:25], v8 offset:8192
    ds_read_b64_tr_b16 v[26:27], v8 offset:10240
    v_mul_f32 v223, v223, v51
    v_mfma_f32_16x16x32_bf16 v[200:203], v[36:39], v[152:155], v[200:203]
    ds_read_b64_tr_b16 v[28:29], v8 offset:12288
    ds_read_b64_tr_b16 v[30:31], v8 offset:14336
    v_cvt_pk_bf16_f32 v208, v208, v209
    v_mfma_f32_16x16x32_bf16 v[204:207], v[36:39], v[156:159], v[204:207]
    v_cvt_pk_bf16_f32 v209, v210, v211
    v_cvt_pk_bf16_f32 v210, v212, v213
    s_waitcnt lgkmcnt(10)
    v_mfma_f32_16x16x32_bf16 v[192:195], v[40:43], v[160:163], v[192:195]
    v_cvt_pk_bf16_f32 v211, v214, v215
    s_mov_b32 s54, 8192
    buffer_store_dwordx4 v[208:211], v57, s[40:43], s54 offen nt
    v_cvt_pk_bf16_f32 v216, v216, v217
    v_mfma_f32_16x16x32_bf16 v[196:199], v[40:43], v[164:167], v[196:199]
    v_cvt_pk_bf16_f32 v217, v218, v219
    v_mfma_f32_16x16x32_bf16 v[200:203], v[40:43], v[168:171], v[200:203]
    v_cvt_pk_bf16_f32 v218, v220, v221
    v_mfma_f32_16x16x32_bf16 v[204:207], v[40:43], v[172:175], v[204:207]
    s_waitcnt lgkmcnt(8)
    v_mfma_f32_16x16x32_bf16 v[192:195], v[44:47], v[176:179], v[192:195]
    v_cvt_pk_bf16_f32 v219, v222, v223
    s_mov_b32 s54, 9216
    buffer_store_dwordx4 v[216:219], v57, s[40:43], s54 offen nt
    v_mfma_f32_16x16x32_bf16 v[196:199], v[44:47], v[180:183], v[196:199]
    v_mfma_f32_16x16x32_bf16 v[200:203], v[44:47], v[184:187], v[200:203]
    v_mfma_f32_16x16x32_bf16 v[204:207], v[44:47], v[188:191], v[204:207]
    s_waitcnt lgkmcnt(6)
    v_mfma_f32_16x16x32_bf16 v[208:211], v[16:19], v[64:67], 0
    v_mfma_f32_16x16x32_bf16 v[212:215], v[16:19], v[68:71], 0
    v_mfma_f32_16x16x32_bf16 v[216:219], v[16:19], v[72:75], 0
    v_mfma_f32_16x16x32_bf16 v[220:223], v[16:19], v[76:79], 0
    s_barrier
    v_add_u32 v8, 0x24000, v56
    ds_read_b64_tr_b16 v[32:33], v8 offset:0
    ds_read_b64_tr_b16 v[34:35], v8 offset:2048
    s_waitcnt lgkmcnt(6)
    v_mfma_f32_16x16x32_bf16 v[208:211], v[20:23], v[80:83], v[208:211]
    ds_read_b64_tr_b16 v[36:37], v8 offset:4096
    ds_read_b64_tr_b16 v[38:39], v8 offset:6144
    v_mfma_f32_16x16x32_bf16 v[212:215], v[20:23], v[84:87], v[212:215]
    ds_read_b64_tr_b16 v[40:41], v8 offset:8192
    ds_read_b64_tr_b16 v[42:43], v8 offset:10240
    v_mfma_f32_16x16x32_bf16 v[216:219], v[20:23], v[88:91], v[216:219]
    ds_read_b64_tr_b16 v[44:45], v8 offset:12288
    ds_read_b64_tr_b16 v[46:47], v8 offset:14336
    v_mfma_f32_16x16x32_bf16 v[220:223], v[20:23], v[92:95], v[220:223]
    v_mul_f32 v192, v192, v48
    v_mul_f32 v193, v193, v48
    s_waitcnt lgkmcnt(10)
    v_mfma_f32_16x16x32_bf16 v[208:211], v[24:27], v[96:99], v[208:211]
    v_mul_f32 v194, v194, v48
    v_mfma_f32_16x16x32_bf16 v[212:215], v[24:27], v[100:103], v[212:215]
    v_mul_f32 v195, v195, v48
    v_mfma_f32_16x16x32_bf16 v[216:219], v[24:27], v[104:107], v[216:219]
    v_mul_f32 v196, v196, v49
    v_mul_f32 v197, v197, v49
    v_mfma_f32_16x16x32_bf16 v[220:223], v[24:27], v[108:111], v[220:223]
    v_mul_f32 v198, v198, v49
    s_waitcnt lgkmcnt(8)
    v_mfma_f32_16x16x32_bf16 v[208:211], v[28:31], v[112:115], v[208:211]
    v_mul_f32 v199, v199, v49
    v_mfma_f32_16x16x32_bf16 v[212:215], v[28:31], v[116:119], v[212:215]
    v_mul_f32 v200, v200, v50
    v_mfma_f32_16x16x32_bf16 v[216:219], v[28:31], v[120:123], v[216:219]
    v_mul_f32 v201, v201, v50
    v_mfma_f32_16x16x32_bf16 v[220:223], v[28:31], v[124:127], v[220:223]
    v_mul_f32 v202, v202, v50
    s_waitcnt lgkmcnt(6)
    v_mfma_f32_16x16x32_bf16 v[208:211], v[32:35], v[128:131], v[208:211]
    v_mul_f32 v203, v203, v50
    v_mfma_f32_16x16x32_bf16 v[212:215], v[32:35], v[132:135], v[212:215]
    v_mul_f32 v204, v204, v51
    v_mfma_f32_16x16x32_bf16 v[216:219], v[32:35], v[136:139], v[216:219]
    v_mul_f32 v205, v205, v51
    v_mfma_f32_16x16x32_bf16 v[220:223], v[32:35], v[140:143], v[220:223]
    s_barrier
    v_add_u32 v8, 0x10000, v56
    ds_read_b64_tr_b16 v[16:17], v8 offset:0
    ds_read_b64_tr_b16 v[18:19], v8 offset:2048
    s_waitcnt lgkmcnt(6)
    v_mfma_f32_16x16x32_bf16 v[208:211], v[36:39], v[144:147], v[208:211]
    ds_read_b64_tr_b16 v[20:21], v8 offset:4096
    ds_read_b64_tr_b16 v[22:23], v8 offset:6144
    v_mul_f32 v206, v206, v51
    v_mfma_f32_16x16x32_bf16 v[212:215], v[36:39], v[148:151], v[212:215]
    ds_read_b64_tr_b16 v[24:25], v8 offset:8192
    ds_read_b64_tr_b16 v[26:27], v8 offset:10240
    v_mul_f32 v207, v207, v51
    v_mfma_f32_16x16x32_bf16 v[216:219], v[36:39], v[152:155], v[216:219]
    ds_read_b64_tr_b16 v[28:29], v8 offset:12288
    ds_read_b64_tr_b16 v[30:31], v8 offset:14336
    v_cvt_pk_bf16_f32 v192, v192, v193
    v_mfma_f32_16x16x32_bf16 v[220:223], v[36:39], v[156:159], v[220:223]
    v_cvt_pk_bf16_f32 v193, v194, v195
    v_cvt_pk_bf16_f32 v194, v196, v197
    s_waitcnt lgkmcnt(10)
    v_mfma_f32_16x16x32_bf16 v[208:211], v[40:43], v[160:163], v[208:211]
    v_cvt_pk_bf16_f32 v195, v198, v199
    s_mov_b32 s54, 16384
    buffer_store_dwordx4 v[192:195], v57, s[40:43], s54 offen nt
    v_cvt_pk_bf16_f32 v200, v200, v201
    v_mfma_f32_16x16x32_bf16 v[212:215], v[40:43], v[164:167], v[212:215]
    v_cvt_pk_bf16_f32 v201, v202, v203
    v_mfma_f32_16x16x32_bf16 v[216:219], v[40:43], v[168:171], v[216:219]
    v_cvt_pk_bf16_f32 v202, v204, v205
    v_mfma_f32_16x16x32_bf16 v[220:223], v[40:43], v[172:175], v[220:223]
    s_waitcnt lgkmcnt(8)
    v_mfma_f32_16x16x32_bf16 v[208:211], v[44:47], v[176:179], v[208:211]
    v_cvt_pk_bf16_f32 v203, v206, v207
    s_mov_b32 s54, 17408
    buffer_store_dwordx4 v[200:203], v57, s[40:43], s54 offen nt
    v_mfma_f32_16x16x32_bf16 v[212:215], v[44:47], v[180:183], v[212:215]
    v_mfma_f32_16x16x32_bf16 v[216:219], v[44:47], v[184:187], v[216:219]
    v_mfma_f32_16x16x32_bf16 v[220:223], v[44:47], v[188:191], v[220:223]
    s_waitcnt lgkmcnt(6)
    v_mfma_f32_16x16x32_bf16 v[192:195], v[16:19], v[64:67], 0
    v_mfma_f32_16x16x32_bf16 v[196:199], v[16:19], v[68:71], 0
    v_mfma_f32_16x16x32_bf16 v[200:203], v[16:19], v[72:75], 0
    v_mfma_f32_16x16x32_bf16 v[204:207], v[16:19], v[76:79], 0
    s_barrier
    v_add_u32 v8, 0x14000, v56
    ds_read_b64_tr_b16 v[32:33], v8 offset:0
    ds_read_b64_tr_b16 v[34:35], v8 offset:2048
    s_waitcnt lgkmcnt(6)
    v_mfma_f32_16x16x32_bf16 v[192:195], v[20:23], v[80:83], v[192:195]
    ds_read_b64_tr_b16 v[36:37], v8 offset:4096
    ds_read_b64_tr_b16 v[38:39], v8 offset:6144
    v_mfma_f32_16x16x32_bf16 v[196:199], v[20:23], v[84:87], v[196:199]
    ds_read_b64_tr_b16 v[40:41], v8 offset:8192
    ds_read_b64_tr_b16 v[42:43], v8 offset:10240
    v_mfma_f32_16x16x32_bf16 v[200:203], v[20:23], v[88:91], v[200:203]
    ds_read_b64_tr_b16 v[44:45], v8 offset:12288
    ds_read_b64_tr_b16 v[46:47], v8 offset:14336
    v_mfma_f32_16x16x32_bf16 v[204:207], v[20:23], v[92:95], v[204:207]
    v_mul_f32 v208, v208, v48
    v_mul_f32 v209, v209, v48
    s_waitcnt lgkmcnt(10)
    v_mfma_f32_16x16x32_bf16 v[192:195], v[24:27], v[96:99], v[192:195]
    v_mul_f32 v210, v210, v48
    v_mfma_f32_16x16x32_bf16 v[196:199], v[24:27], v[100:103], v[196:199]
    v_mul_f32 v211, v211, v48
    v_mfma_f32_16x16x32_bf16 v[200:203], v[24:27], v[104:107], v[200:203]
    v_mul_f32 v212, v212, v49
    v_mul_f32 v213, v213, v49
    v_mfma_f32_16x16x32_bf16 v[204:207], v[24:27], v[108:111], v[204:207]
    v_mul_f32 v214, v214, v49
    s_waitcnt lgkmcnt(8)
    v_mfma_f32_16x16x32_bf16 v[192:195], v[28:31], v[112:115], v[192:195]
    v_mul_f32 v215, v215, v49
    v_mfma_f32_16x16x32_bf16 v[196:199], v[28:31], v[116:119], v[196:199]
    v_mul_f32 v216, v216, v50
    v_mfma_f32_16x16x32_bf16 v[200:203], v[28:31], v[120:123], v[200:203]
    v_mul_f32 v217, v217, v50
    v_mfma_f32_16x16x32_bf16 v[204:207], v[28:31], v[124:127], v[204:207]
    v_mul_f32 v218, v218, v50
    s_waitcnt lgkmcnt(6)
    v_mfma_f32_16x16x32_bf16 v[192:195], v[32:35], v[128:131], v[192:195]
    v_mul_f32 v219, v219, v50
    v_mfma_f32_16x16x32_bf16 v[196:199], v[32:35], v[132:135], v[196:199]
    v_mul_f32 v220, v220, v51
    v_mfma_f32_16x16x32_bf16 v[200:203], v[32:35], v[136:139], v[200:203]
    v_mul_f32 v221, v221, v51
    v_mfma_f32_16x16x32_bf16 v[204:207], v[32:35], v[140:143], v[204:207]
    s_barrier
    v_add_u32 v8, 0x18000, v56
    ds_read_b64_tr_b16 v[16:17], v8 offset:0
    ds_read_b64_tr_b16 v[18:19], v8 offset:2048
    s_waitcnt lgkmcnt(6)
    v_mfma_f32_16x16x32_bf16 v[192:195], v[36:39], v[144:147], v[192:195]
    ds_read_b64_tr_b16 v[20:21], v8 offset:4096
    ds_read_b64_tr_b16 v[22:23], v8 offset:6144
    v_mul_f32 v222, v222, v51
    v_mfma_f32_16x16x32_bf16 v[196:199], v[36:39], v[148:151], v[196:199]
    ds_read_b64_tr_b16 v[24:25], v8 offset:8192
    ds_read_b64_tr_b16 v[26:27], v8 offset:10240
    v_mul_f32 v223, v223, v51
    v_mfma_f32_16x16x32_bf16 v[200:203], v[36:39], v[152:155], v[200:203]
    ds_read_b64_tr_b16 v[28:29], v8 offset:12288
    ds_read_b64_tr_b16 v[30:31], v8 offset:14336
    v_cvt_pk_bf16_f32 v208, v208, v209
    v_mfma_f32_16x16x32_bf16 v[204:207], v[36:39], v[156:159], v[204:207]
    v_cvt_pk_bf16_f32 v209, v210, v211
    v_cvt_pk_bf16_f32 v210, v212, v213
    s_waitcnt lgkmcnt(10)
    v_mfma_f32_16x16x32_bf16 v[192:195], v[40:43], v[160:163], v[192:195]
    v_cvt_pk_bf16_f32 v211, v214, v215
    s_mov_b32 s54, 24576
    buffer_store_dwordx4 v[208:211], v57, s[40:43], s54 offen nt
    v_cvt_pk_bf16_f32 v216, v216, v217
    v_mfma_f32_16x16x32_bf16 v[196:199], v[40:43], v[164:167], v[196:199]
    v_cvt_pk_bf16_f32 v217, v218, v219
    v_mfma_f32_16x16x32_bf16 v[200:203], v[40:43], v[168:171], v[200:203]
    v_cvt_pk_bf16_f32 v218, v220, v221
    v_mfma_f32_16x16x32_bf16 v[204:207], v[40:43], v[172:175], v[204:207]
    s_waitcnt lgkmcnt(8)
    v_mfma_f32_16x16x32_bf16 v[192:195], v[44:47], v[176:179], v[192:195]
    v_cvt_pk_bf16_f32 v219, v222, v223
    s_mov_b32 s54, 25600
    buffer_store_dwordx4 v[216:219], v57, s[40:43], s54 offen nt
    v_mfma_f32_16x16x32_bf16 v[196:199], v[44:47], v[180:183], v[196:199]
    v_mfma_f32_16x16x32_bf16 v[200:203], v[44:47], v[184:187], v[200:203]
    v_mfma_f32_16x16x32_bf16 v[204:207], v[44:47], v[188:191], v[204:207]
    s_waitcnt lgkmcnt(6)
    v_mfma_f32_16x16x32_bf16 v[208:211], v[16:19], v[64:67], 0
    v_mfma_f32_16x16x32_bf16 v[212:215], v[16:19], v[68:71], 0
    v_mfma_f32_16x16x32_bf16 v[216:219], v[16:19], v[72:75], 0
    v_mfma_f32_16x16x32_bf16 v[220:223], v[16:19], v[76:79], 0
    s_barrier
    v_add_u32 v8, 0x1c000, v56
    ds_read_b64_tr_b16 v[32:33], v8 offset:0
    ds_read_b64_tr_b16 v[34:35], v8 offset:2048
    s_waitcnt lgkmcnt(6)
    v_mfma_f32_16x16x32_bf16 v[208:211], v[20:23], v[80:83], v[208:211]
    ds_read_b64_tr_b16 v[36:37], v8 offset:4096
    ds_read_b64_tr_b16 v[38:39], v8 offset:6144
    v_mfma_f32_16x16x32_bf16 v[212:215], v[20:23], v[84:87], v[212:215]
    ds_read_b64_tr_b16 v[40:41], v8 offset:8192
    ds_read_b64_tr_b16 v[42:43], v8 offset:10240
    v_mfma_f32_16x16x32_bf16 v[216:219], v[20:23], v[88:91], v[216:219]
    ds_read_b64_tr_b16 v[44:45], v8 offset:12288
    ds_read_b64_tr_b16 v[46:47], v8 offset:14336
    v_mfma_f32_16x16x32_bf16 v[220:223], v[20:23], v[92:95], v[220:223]
    v_mul_f32 v192, v192, v48
    v_mul_f32 v193, v193, v48
    s_waitcnt lgkmcnt(10)
    v_mfma_f32_16x16x32_bf16 v[208:211], v[24:27], v[96:99], v[208:211]
    v_mul_f32 v194, v194, v48
    v_mfma_f32_16x16x32_bf16 v[212:215], v[24:27], v[100:103], v[212:215]
    v_mul_f32 v195, v195, v48
    v_mfma_f32_16x16x32_bf16 v[216:219], v[24:27], v[104:107], v[216:219]
    v_mul_f32 v196, v196, v49
    v_mul_f32 v197, v197, v49
    v_mfma_f32_16x16x32_bf16 v[220:223], v[24:27], v[108:111], v[220:223]
    v_mul_f32 v198, v198, v49
    s_waitcnt lgkmcnt(8)
    v_mfma_f32_16x16x32_bf16 v[208:211], v[28:31], v[112:115], v[208:211]
    v_mul_f32 v199, v199, v49
    v_mfma_f32_16x16x32_bf16 v[212:215], v[28:31], v[116:119], v[212:215]
    v_mul_f32 v200, v200, v50
    v_mfma_f32_16x16x32_bf16 v[216:219], v[28:31], v[120:123], v[216:219]
    v_mul_f32 v201, v201, v50
    v_mfma_f32_16x16x32_bf16 v[220:223], v[28:31], v[124:127], v[220:223]
    v_mul_f32 v202, v202, v50
    s_waitcnt lgkmcnt(6)
    v_mfma_f32_16x16x32_bf16 v[208:211], v[32:35], v[128:131], v[208:211]
    v_mul_f32 v203, v203, v50
    v_mfma_f32_16x16x32_bf16 v[212:215], v[32:35], v[132:135], v[212:215]
    v_mul_f32 v204, v204, v51
    v_mfma_f32_16x16x32_bf16 v[216:219], v[32:35], v[136:139], v[216:219]
    v_mul_f32 v205, v205, v51
    v_mfma_f32_16x16x32_bf16 v[220:223], v[32:35], v[140:143], v[220:223]
    s_barrier
    v_add_u32 v8, 0x8000, v56
    ds_read_b64_tr_b16 v[16:17], v8 offset:0
    ds_read_b64_tr_b16 v[18:19], v8 offset:2048
    s_waitcnt lgkmcnt(6)
    v_mfma_f32_16x16x32_bf16 v[208:211], v[36:39], v[144:147], v[208:211]
    ds_read_b64_tr_b16 v[20:21], v8 offset:4096
    ds_read_b64_tr_b16 v[22:23], v8 offset:6144
    v_mul_f32 v206, v206, v51
    v_mfma_f32_16x16x32_bf16 v[212:215], v[36:39], v[148:151], v[212:215]
    ds_read_b64_tr_b16 v[24:25], v8 offset:8192
    ds_read_b64_tr_b16 v[26:27], v8 offset:10240
    v_mul_f32 v207, v207, v51
    v_mfma_f32_16x16x32_bf16 v[216:219], v[36:39], v[152:155], v[216:219]
    ds_read_b64_tr_b16 v[28:29], v8 offset:12288
    ds_read_b64_tr_b16 v[30:31], v8 offset:14336
    v_cvt_pk_bf16_f32 v192, v192, v193
    v_mfma_f32_16x16x32_bf16 v[220:223], v[36:39], v[156:159], v[220:223]
    v_cvt_pk_bf16_f32 v193, v194, v195
    v_cvt_pk_bf16_f32 v194, v196, v197
    s_waitcnt lgkmcnt(10)
    v_mfma_f32_16x16x32_bf16 v[208:211], v[40:43], v[160:163], v[208:211]
    v_cvt_pk_bf16_f32 v195, v198, v199
    s_mov_b32 s54, 32768
    buffer_store_dwordx4 v[192:195], v57, s[40:43], s54 offen nt
    v_cvt_pk_bf16_f32 v200, v200, v201
    v_mfma_f32_16x16x32_bf16 v[212:215], v[40:43], v[164:167], v[212:215]
    v_cvt_pk_bf16_f32 v201, v202, v203
    v_mfma_f32_16x16x32_bf16 v[216:219], v[40:43], v[168:171], v[216:219]
    v_cvt_pk_bf16_f32 v202, v204, v205
    v_mfma_f32_16x16x32_bf16 v[220:223], v[40:43], v[172:175], v[220:223]
    s_waitcnt lgkmcnt(8)
    v_mfma_f32_16x16x32_bf16 v[208:211], v[44:47], v[176:179], v[208:211]
    v_cvt_pk_bf16_f32 v203, v206, v207
    s_mov_b32 s54, 33792
    buffer_store_dwordx4 v[200:203], v57, s[40:43], s54 offen nt
    v_mfma_f32_16x16x32_bf16 v[212:215], v[44:47], v[180:183], v[212:215]
    v_mfma_f32_16x16x32_bf16 v[216:219], v[44:47], v[184:187], v[216:219]
    v_mfma_f32_16x16x32_bf16 v[220:223], v[44:47], v[188:191], v[220:223]
    s_waitcnt lgkmcnt(6)
    v_mfma_f32_16x16x32_bf16 v[192:195], v[16:19], v[64:67], 0
    v_mfma_f32_16x16x32_bf16 v[196:199], v[16:19], v[68:71], 0
    v_mfma_f32_16x16x32_bf16 v[200:203], v[16:19], v[72:75], 0
    v_mfma_f32_16x16x32_bf16 v[204:207], v[16:19], v[76:79], 0
    s_barrier
    v_add_u32 v8, 0xc000, v56
    ds_read_b64_tr_b16 v[32:33], v8 offset:0
    ds_read_b64_tr_b16 v[34:35], v8 offset:2048
    s_waitcnt lgkmcnt(6)
    v_mfma_f32_16x16x32_bf16 v[192:195], v[20:23], v[80:83], v[192:195]
    ds_read_b64_tr_b16 v[36:37], v8 offset:4096
    ds_read_b64_tr_b16 v[38:39], v8 offset:6144
    v_mfma_f32_16x16x32_bf16 v[196:199], v[20:23], v[84:87], v[196:199]
    ds_read_b64_tr_b16 v[40:41], v8 offset:8192
    ds_read_b64_tr_b16 v[42:43], v8 offset:10240
    v_mfma_f32_16x16x32_bf16 v[200:203], v[20:23], v[88:91], v[200:203]
    ds_read_b64_tr_b16 v[44:45], v8 offset:12288
    ds_read_b64_tr_b16 v[46:47], v8 offset:14336
    v_mfma_f32_16x16x32_bf16 v[204:207], v[20:23], v[92:95], v[204:207]
    v_mul_f32 v208, v208, v48
    v_mul_f32 v209, v209, v48
    s_waitcnt lgkmcnt(10)
    v_mfma_f32_16x16x32_bf16 v[192:195], v[24:27], v[96:99], v[192:195]
    v_mul_f32 v210, v210, v48
    v_mfma_f32_16x16x32_bf16 v[196:199], v[24:27], v[100:103], v[196:199]
    v_mul_f32 v211, v211, v48
    v_mfma_f32_16x16x32_bf16 v[200:203], v[24:27], v[104:107], v[200:203]
    v_mul_f32 v212, v212, v49
    v_mul_f32 v213, v213, v49
    v_mfma_f32_16x16x32_bf16 v[204:207], v[24:27], v[108:111], v[204:207]
    v_mul_f32 v214, v214, v49
    s_waitcnt lgkmcnt(8)
    v_mfma_f32_16x16x32_bf16 v[192:195], v[28:31], v[112:115], v[192:195]
    v_mul_f32 v215, v215, v49
    v_mfma_f32_16x16x32_bf16 v[196:199], v[28:31], v[116:119], v[196:199]
    v_mul_f32 v216, v216, v50
    v_mfma_f32_16x16x32_bf16 v[200:203], v[28:31], v[120:123], v[200:203]
    v_mul_f32 v217, v217, v50
    v_mfma_f32_16x16x32_bf16 v[204:207], v[28:31], v[124:127], v[204:207]
    v_mul_f32 v218, v218, v50
    s_waitcnt lgkmcnt(6)
    v_mfma_f32_16x16x32_bf16 v[192:195], v[32:35], v[128:131], v[192:195]
    v_mul_f32 v219, v219, v50
    v_mfma_f32_16x16x32_bf16 v[196:199], v[32:35], v[132:135], v[196:199]
    v_mul_f32 v220, v220, v51
    v_mfma_f32_16x16x32_bf16 v[200:203], v[32:35], v[136:139], v[200:203]
    v_mul_f32 v221, v221, v51
    v_mfma_f32_16x16x32_bf16 v[204:207], v[32:35], v[140:143], v[204:207]
    v_mul_f32 v222, v222, v51
    s_waitcnt lgkmcnt(4)
    v_mfma_f32_16x16x32_bf16 v[192:195], v[36:39], v[144:147], v[192:195]
    v_mul_f32 v223, v223, v51
    v_mfma_f32_16x16x32_bf16 v[196:199], v[36:39], v[148:151], v[196:199]
    v_cvt_pk_bf16_f32 v208, v208, v209
    v_mfma_f32_16x16x32_bf16 v[200:203], v[36:39], v[152:155], v[200:203]
    v_cvt_pk_bf16_f32 v209, v210, v211
    v_cvt_pk_bf16_f32 v210, v212, v213
    v_mfma_f32_16x16x32_bf16 v[204:207], v[36:39], v[156:159], v[204:207]
    v_cvt_pk_bf16_f32 v211, v214, v215
    s_waitcnt lgkmcnt(2)
    v_mfma_f32_16x16x32_bf16 v[192:195], v[40:43], v[160:163], v[192:195]
    s_mov_b32 s54, 40960
    buffer_store_dwordx4 v[208:211], v57, s[40:43], s54 offen nt
    v_mfma_f32_16x16x32_bf16 v[196:199], v[40:43], v[164:167], v[196:199]
    v_cvt_pk_bf16_f32 v216, v216, v217
    v_mfma_f32_16x16x32_bf16 v[200:203], v[40:43], v[168:171], v[200:203]
    v_cvt_pk_bf16_f32 v217, v218, v219
    v_mfma_f32_16x16x32_bf16 v[204:207], v[40:43], v[172:175], v[204:207]
    v_cvt_pk_bf16_f32 v218, v220, v221
    v_cvt_pk_bf16_f32 v219, v222, v223
    s_waitcnt lgkmcnt(0)
    v_mfma_f32_16x16x32_bf16 v[192:195], v[44:47], v[176:179], v[192:195]
    s_mov_b32 s54, 41984
    buffer_store_dwordx4 v[216:219], v57, s[40:43], s54 offen nt
    v_mfma_f32_16x16x32_bf16 v[196:199], v[44:47], v[180:183], v[196:199]
    v_mfma_f32_16x16x32_bf16 v[200:203], v[44:47], v[184:187], v[200:203]
    v_mfma_f32_16x16x32_bf16 v[204:207], v[44:47], v[188:191], v[204:207]
    s_nop 7
    s_nop 1
    v_mul_f32 v192, v192, v48
    v_mul_f32 v193, v193, v48
    v_mul_f32 v194, v194, v48
    v_mul_f32 v195, v195, v48
    v_mul_f32 v196, v196, v49
    v_mul_f32 v197, v197, v49
    v_mul_f32 v198, v198, v49
    v_mul_f32 v199, v199, v49
    v_mul_f32 v200, v200, v50
    v_mul_f32 v201, v201, v50
    v_mul_f32 v202, v202, v50
    v_mul_f32 v203, v203, v50
    v_mul_f32 v204, v204, v51
    v_mul_f32 v205, v205, v51
    v_mul_f32 v206, v206, v51
    v_mul_f32 v207, v207, v51
    v_cvt_pk_bf16_f32 v192, v192, v193
    v_cvt_pk_bf16_f32 v193, v194, v195
    v_cvt_pk_bf16_f32 v194, v196, v197
    v_cvt_pk_bf16_f32 v195, v198, v199
    s_mov_b32 s54, 49152
    buffer_store_dwordx4 v[192:195], v57, s[40:43], s54 offen nt
    v_cvt_pk_bf16_f32 v200, v200, v201
    v_cvt_pk_bf16_f32 v201, v202, v203
    v_cvt_pk_bf16_f32 v202, v204, v205
    v_cvt_pk_bf16_f32 v203, v206, v207
    s_mov_b32 s54, 50176
    buffer_store_dwordx4 v[200:203], v57, s[40:43], s54 offen nt
K1_EXIT:
    s_endpgm
.globl k2_kernel
.p2align 8
.type k2_kernel,@function
k2_kernel:
    s_cmp_ge_u32 s2, 224
    s_cbranch_scc1 K2_END
    s_load_dwordx2 s[4:5], s[0:1], 40
    s_load_dwordx2 s[6:7], s[0:1], 56
    v_lshrrev_b32 v1, 6, v0
    v_and_b32 v0, 63, v0
    v_readfirstlane_b32 s3, v1
    s_lshl_b32 s8, s2, 2
    s_add_u32 s8, s8, s3
    s_mul_i32 s9, s8, 9363
    s_lshr_b32 s9, s9, 19
    s_mul_i32 s10, s9, 56
    s_sub_u32 s10, s8, s10
    s_mul_i32 s11, s9, 917504
    s_lshl_b32 s12, s10, 10
    s_add_u32 s11, s11, s12
    v_lshlrev_b32 v2, 4, v0
    s_mov_b32 s18, 917504
    s_mov_b32 s19, 0x00020000
    s_mov_b32 s20, 0
    s_waitcnt lgkmcnt(0)
    s_add_u32 s16, s6, s11
    s_addc_u32 s17, s7, 0
    buffer_load_dwordx4 v[16:19], v2, s[16:19], s20 offen
    s_add_u32 s20, s20, 57344
    buffer_load_dwordx4 v[20:23], v2, s[16:19], s20 offen
    s_add_u32 s20, s20, 57344
    buffer_load_dwordx4 v[24:27], v2, s[16:19], s20 offen
    s_add_u32 s20, s20, 57344
    buffer_load_dwordx4 v[28:31], v2, s[16:19], s20 offen
    s_add_u32 s20, s20, 57344
    buffer_load_dwordx4 v[32:35], v2, s[16:19], s20 offen
    s_add_u32 s20, s20, 57344
    buffer_load_dwordx4 v[36:39], v2, s[16:19], s20 offen
    s_add_u32 s20, s20, 57344
    buffer_load_dwordx4 v[40:43], v2, s[16:19], s20 offen
    s_add_u32 s20, s20, 57344
    buffer_load_dwordx4 v[44:47], v2, s[16:19], s20 offen
    s_add_u32 s20, s20, 57344
    buffer_load_dwordx4 v[48:51], v2, s[16:19], s20 offen
    s_add_u32 s20, s20, 57344
    buffer_load_dwordx4 v[52:55], v2, s[16:19], s20 offen
    s_add_u32 s20, s20, 57344
    buffer_load_dwordx4 v[56:59], v2, s[16:19], s20 offen
    s_add_u32 s20, s20, 57344
    buffer_load_dwordx4 v[60:63], v2, s[16:19], s20 offen
    s_add_u32 s20, s20, 57344
    buffer_load_dwordx4 v[64:67], v2, s[16:19], s20 offen
    s_add_u32 s20, s20, 57344
    buffer_load_dwordx4 v[68:71], v2, s[16:19], s20 offen
    s_add_u32 s20, s20, 57344
    buffer_load_dwordx4 v[72:75], v2, s[16:19], s20 offen
    s_add_u32 s20, s20, 57344
    buffer_load_dwordx4 v[76:79], v2, s[16:19], s20 offen
    s_and_b32 s22, s10, 1
    s_bfe_u32 s23, s10, 0x20001
    s_lshr_b32 s24, s10, 3
    s_lshl_b32 s25, s22, 5
    s_lshl_b32 s26, s9, 6
    s_add_u32 s25, s25, s26
    s_lshl_b32 s26, s24, 6
    s_lshl_b32 s27, s23, 4
    s_add_u32 s26, s26, s27
    s_mul_i32 s25, s25, 896
    s_lshl_b32 s26, s26, 1
    s_add_u32 s25, s25, s26
    v_and_b32 v3, 31, v0
    v_mul_u32_u24 v3, 896, v3
    v_lshrrev_b32 v4, 5, v0
    v_lshl_add_u32 v3, v4, 4, v3
    v_add_u32 v3, s25, v3
    s_mov_b32 s28, s4
    s_mov_b32 s29, s5
    s_mov_b32 s30, 917504
    s_mov_b32 s31, 0x00020000
    s_mov_b32 s32, 0x00003f80
    s_mov_b32 s33, 0x3f800000
    v_mov_b32 v4, 0
    v_mov_b32 v5, 0
    v_mov_b32 v6, 0
    v_mov_b32 v7, 0
    v_mov_b32 v8, 0
    v_mov_b32 v9, 0
    v_mov_b32 v10, 0
    v_mov_b32 v11, 0
    s_waitcnt vmcnt(15)
    v_dot2c_f32_bf16 v4, s32, v16
    v_dot2c_f32_bf16 v5, s33, v16
    v_dot2c_f32_bf16 v6, s32, v17
    v_dot2c_f32_bf16 v7, s33, v17
    v_dot2c_f32_bf16 v8, s32, v18
    v_dot2c_f32_bf16 v9, s33, v18
    v_dot2c_f32_bf16 v10, s32, v19
    v_dot2c_f32_bf16 v11, s33, v19
    s_waitcnt vmcnt(14)
    v_dot2c_f32_bf16 v4, s32, v20
    v_dot2c_f32_bf16 v5, s33, v20
    v_dot2c_f32_bf16 v6, s32, v21
    v_dot2c_f32_bf16 v7, s33, v21
    v_dot2c_f32_bf16 v8, s32, v22
    v_dot2c_f32_bf16 v9, s33, v22
    v_dot2c_f32_bf16 v10, s32, v23
    v_dot2c_f32_bf16 v11, s33, v23
    s_waitcnt vmcnt(13)
    v_dot2c_f32_bf16 v4, s32, v24
    v_dot2c_f32_bf16 v5, s33, v24
    v_dot2c_f32_bf16 v6, s32, v25
    v_dot2c_f32_bf16 v7, s33, v25
    v_dot2c_f32_bf16 v8, s32, v26
    v_dot2c_f32_bf16 v9, s33, v26
    v_dot2c_f32_bf16 v10, s32, v27
    v_dot2c_f32_bf16 v11, s33, v27
    s_waitcnt vmcnt(12)
    v_dot2c_f32_bf16 v4, s32, v28
    v_dot2c_f32_bf16 v5, s33, v28
    v_dot2c_f32_bf16 v6, s32, v29
    v_dot2c_f32_bf16 v7, s33, v29
    v_dot2c_f32_bf16 v8, s32, v30
    v_dot2c_f32_bf16 v9, s33, v30
    v_dot2c_f32_bf16 v10, s32, v31
    v_dot2c_f32_bf16 v11, s33, v31
    s_waitcnt vmcnt(11)
    v_dot2c_f32_bf16 v4, s32, v32
    v_dot2c_f32_bf16 v5, s33, v32
    v_dot2c_f32_bf16 v6, s32, v33
    v_dot2c_f32_bf16 v7, s33, v33
    v_dot2c_f32_bf16 v8, s32, v34
    v_dot2c_f32_bf16 v9, s33, v34
    v_dot2c_f32_bf16 v10, s32, v35
    v_dot2c_f32_bf16 v11, s33, v35
    s_waitcnt vmcnt(10)
    v_dot2c_f32_bf16 v4, s32, v36
    v_dot2c_f32_bf16 v5, s33, v36
    v_dot2c_f32_bf16 v6, s32, v37
    v_dot2c_f32_bf16 v7, s33, v37
    v_dot2c_f32_bf16 v8, s32, v38
    v_dot2c_f32_bf16 v9, s33, v38
    v_dot2c_f32_bf16 v10, s32, v39
    v_dot2c_f32_bf16 v11, s33, v39
    s_waitcnt vmcnt(9)
    v_dot2c_f32_bf16 v4, s32, v40
    v_dot2c_f32_bf16 v5, s33, v40
    v_dot2c_f32_bf16 v6, s32, v41
    v_dot2c_f32_bf16 v7, s33, v41
    v_dot2c_f32_bf16 v8, s32, v42
    v_dot2c_f32_bf16 v9, s33, v42
    v_dot2c_f32_bf16 v10, s32, v43
    v_dot2c_f32_bf16 v11, s33, v43
    s_waitcnt vmcnt(8)
    v_dot2c_f32_bf16 v4, s32, v44
    v_dot2c_f32_bf16 v5, s33, v44
    v_dot2c_f32_bf16 v6, s32, v45
    v_dot2c_f32_bf16 v7, s33, v45
    v_dot2c_f32_bf16 v8, s32, v46
    v_dot2c_f32_bf16 v9, s33, v46
    v_dot2c_f32_bf16 v10, s32, v47
    v_dot2c_f32_bf16 v11, s33, v47
    s_waitcnt vmcnt(7)
    v_dot2c_f32_bf16 v4, s32, v48
    v_dot2c_f32_bf16 v5, s33, v48
    v_dot2c_f32_bf16 v6, s32, v49
    v_dot2c_f32_bf16 v7, s33, v49
    v_dot2c_f32_bf16 v8, s32, v50
    v_dot2c_f32_bf16 v9, s33, v50
    v_dot2c_f32_bf16 v10, s32, v51
    v_dot2c_f32_bf16 v11, s33, v51
    s_waitcnt vmcnt(6)
    v_dot2c_f32_bf16 v4, s32, v52
    v_dot2c_f32_bf16 v5, s33, v52
    v_dot2c_f32_bf16 v6, s32, v53
    v_dot2c_f32_bf16 v7, s33, v53
    v_dot2c_f32_bf16 v8, s32, v54
    v_dot2c_f32_bf16 v9, s33, v54
    v_dot2c_f32_bf16 v10, s32, v55
    v_dot2c_f32_bf16 v11, s33, v55
    s_waitcnt vmcnt(5)
    v_dot2c_f32_bf16 v4, s32, v56
    v_dot2c_f32_bf16 v5, s33, v56
    v_dot2c_f32_bf16 v6, s32, v57
    v_dot2c_f32_bf16 v7, s33, v57
    v_dot2c_f32_bf16 v8, s32, v58
    v_dot2c_f32_bf16 v9, s33, v58
    v_dot2c_f32_bf16 v10, s32, v59
    v_dot2c_f32_bf16 v11, s33, v59
    s_waitcnt vmcnt(4)
    v_dot2c_f32_bf16 v4, s32, v60
    v_dot2c_f32_bf16 v5, s33, v60
    v_dot2c_f32_bf16 v6, s32, v61
    v_dot2c_f32_bf16 v7, s33, v61
    v_dot2c_f32_bf16 v8, s32, v62
    v_dot2c_f32_bf16 v9, s33, v62
    v_dot2c_f32_bf16 v10, s32, v63
    v_dot2c_f32_bf16 v11, s33, v63
    s_waitcnt vmcnt(3)
    v_dot2c_f32_bf16 v4, s32, v64
    v_dot2c_f32_bf16 v5, s33, v64
    v_dot2c_f32_bf16 v6, s32, v65
    v_dot2c_f32_bf16 v7, s33, v65
    v_dot2c_f32_bf16 v8, s32, v66
    v_dot2c_f32_bf16 v9, s33, v66
    v_dot2c_f32_bf16 v10, s32, v67
    v_dot2c_f32_bf16 v11, s33, v67
    s_waitcnt vmcnt(2)
    v_dot2c_f32_bf16 v4, s32, v68
    v_dot2c_f32_bf16 v5, s33, v68
    v_dot2c_f32_bf16 v6, s32, v69
    v_dot2c_f32_bf16 v7, s33, v69
    v_dot2c_f32_bf16 v8, s32, v70
    v_dot2c_f32_bf16 v9, s33, v70
    v_dot2c_f32_bf16 v10, s32, v71
    v_dot2c_f32_bf16 v11, s33, v71
    s_waitcnt vmcnt(1)
    v_dot2c_f32_bf16 v4, s32, v72
    v_dot2c_f32_bf16 v5, s33, v72
    v_dot2c_f32_bf16 v6, s32, v73
    v_dot2c_f32_bf16 v7, s33, v73
    v_dot2c_f32_bf16 v8, s32, v74
    v_dot2c_f32_bf16 v9, s33, v74
    v_dot2c_f32_bf16 v10, s32, v75
    v_dot2c_f32_bf16 v11, s33, v75
    s_waitcnt vmcnt(0)
    v_dot2c_f32_bf16 v4, s32, v76
    v_dot2c_f32_bf16 v5, s33, v76
    v_dot2c_f32_bf16 v6, s32, v77
    v_dot2c_f32_bf16 v7, s33, v77
    v_dot2c_f32_bf16 v8, s32, v78
    v_dot2c_f32_bf16 v9, s33, v78
    v_dot2c_f32_bf16 v10, s32, v79
    v_dot2c_f32_bf16 v11, s33, v79
    s_nop 2
    v_cvt_pk_bf16_f32 v12, v4, v5
    v_cvt_pk_bf16_f32 v13, v6, v7
    v_cvt_pk_bf16_f32 v14, v8, v9
    v_cvt_pk_bf16_f32 v15, v10, v11
    s_nop 1
    v_permlane16_swap_b32 v12, v14
    v_permlane16_swap_b32 v13, v15
    buffer_store_dwordx4 v[12:15], v3, s[28:31], 0 offen
K2_END:
    s_endpgm
K_ALL_END:
.section .rodata,"a"
.p2align 6
.amdhsa_kernel k1_kernel
  .amdhsa_next_free_vgpr 256
  .amdhsa_next_free_sgpr 96
  .amdhsa_accum_offset 256
  .amdhsa_group_segment_fixed_size 0
  .amdhsa_kernarg_size 64
  .amdhsa_user_sgpr_count 2
  .amdhsa_user_sgpr_kernarg_segment_ptr 1
  .amdhsa_system_sgpr_workgroup_id_x 1
.end_amdhsa_kernel
.p2align 6
.amdhsa_kernel k2_kernel
  .amdhsa_next_free_vgpr 80
  .amdhsa_next_free_sgpr 48
  .amdhsa_accum_offset 80
  .amdhsa_group_segment_fixed_size 0
  .amdhsa_kernarg_size 64
  .amdhsa_user_sgpr_count 2
  .amdhsa_user_sgpr_kernarg_segment_ptr 1
  .amdhsa_system_sgpr_workgroup_id_x 1
.end_amdhsa_kernel
```
